```python
import torch

def _softmax(x, axis=-1):
    return torch.softmax(x, dim=axis)
def _gelu(x):
    return torch.nn.functional.gelu(x, approximate="tanh")
def _silu(x):
    return torch.nn.functional.silu(x)
def _sigmoid(x):
    return torch.sigmoid(x)
def _layernorm(x, axis=-1, eps=1e-5):
    m = x.mean(dim=axis, keepdim=True)
    v = x.var(dim=axis, keepdim=True, unbiased=False)
    return (x - m) / torch.sqrt(v + eps)
def _scatter_add(tgt, idx, src, axis=0):
    return tgt.clone().index_add_(axis, idx, src)
def _segment_sum(src, seg, n):
    out = torch.zeros((n,) + src.shape[1:], dtype=src.dtype)
    return out.index_add_(0, seg, src)
def _pad(x, pw):
    flat = tuple(v for pair in reversed(pw) for v in pair)
    return torch.nn.functional.pad(x, flat)

kernel_name = 'concat_heads__ssm_conv_s4d__ssm_conv_h3__prompt'

def setup_inputs():

    _w = (lambda a: (lambda t: t.to(torch.bfloat16) if t.is_floating_point() else t)(torch.as_tensor(a)))
    def _A_setup():
        Bsz, L, D, N = 1, 2048, 1024, 128
        return {
            "u": _w((lambda *s: torch.randn(*s, dtype=torch.bfloat16) * 0.05)(Bsz, L, D)),
            "log_A_real": _w((lambda *s: torch.randn(*s, dtype=torch.bfloat16) * 3.2)(D, N) * 0.5),
            "A_imag": _w((lambda *s: torch.randn(*s, dtype=torch.bfloat16) * 0.05)(D, N) * 3.14),
            "C_real": _w((lambda *s: torch.randn(*s, dtype=torch.bfloat16) * 0.1)(D, N) / N ** 0.5),
            "C_imag": _w((lambda *s: torch.randn(*s, dtype=torch.bfloat16) * 0.1)(D, N) / N ** 0.5),
            "log_dt": _w((lambda *s: torch.randn(*s, dtype=torch.bfloat16) * 0.05)(D) * 0.5 - 4.0),
            "D_skip": _w((lambda *s: torch.randn(*s, dtype=torch.bfloat16) * 0.05)(D)),
        }
    _A_in = _A_setup()

    def _B_setup():
        B, S, D = 1, 2048, 1024
        ks = 4
        return {
            "q": _w((lambda *s: torch.randn(*s, dtype=torch.bfloat16) * 0.05)(B, S, D)),
            "k": _w((lambda *s: torch.randn(*s, dtype=torch.bfloat16) * 0.2)(B, S, D)),
            "v": _w((lambda *s: torch.randn(*s, dtype=torch.bfloat16) * 0.2)(B, S, D)),
            "shift_k": _w((lambda *s: torch.randn(*s, dtype=torch.bfloat16) * 0.2)(D, ks) * 0.5),
            "ssm_k": _w((lambda *s: torch.randn(*s, dtype=torch.bfloat16) * 0.8)(D, S) * (1.0 / S ** 0.5)),
            "ssm_D": _w((lambda *s: torch.randn(*s, dtype=torch.bfloat16) * 0.2)(D)),
        }
    _B_in = _B_setup()

    return {
        "A_u": _A_in["u"],
        "A_log_A_real": _A_in["log_A_real"],
        "A_A_imag": _A_in["A_imag"],
        "A_C_real": _A_in["C_real"],
        "A_C_imag": _A_in["C_imag"],
        "A_log_dt": _A_in["log_dt"],
        "A_D_skip": _A_in["D_skip"],
        "B_q": _B_in["q"],
        "B_k": _B_in["k"],
        "B_v": _B_in["v"],
        "B_shift_k": _B_in["shift_k"],
        "B_ssm_k": _B_in["ssm_k"],
        "B_ssm_D": _B_in["ssm_D"],
    }

def reference(A_u, A_log_A_real, A_A_imag, A_C_real, A_C_imag, A_log_dt, A_D_skip, B_q, B_k, B_v, B_shift_k, B_ssm_k, B_ssm_D):
    def _A_ref(u, log_A_real, A_imag, C_real, C_imag, log_dt, D_skip):
        L = u.shape[1]
        dt = torch.exp(log_dt)
        A = -torch.exp(log_A_real) + 1j * A_imag
        C = (C_real + 1j * C_imag) * dt[:, None]
        pos = (lambda x, dt: x.to(dt))(torch.arange(L), log_dt.dtype)
        P = torch.exp((A * dt[:, None])[:, :, None] * pos[None, None, :])
        K = 2.0 * torch.einsum("dn,dnl->dl", C, P).real
        L2 = 2 * L
        u_t = (lambda x, *d: x.permute(*d))(u, 0, 2, 1)
        Kf = (lambda x, *a, **k: torch.fft.rfft(x.float(), *a, **k))(K, L2)
        Uf = (lambda x, *a, **k: torch.fft.rfft(x.float(), *a, **k))(u_t, L2)
        y = (lambda x, *a, **k: torch.fft.irfft(x, *a, **k).to(torch.bfloat16))(Uf * Kf[None, :, :], L2)[:, :, :L]
        y = (lambda x, *d: x.permute(*d))(y, 0, 2, 1)
        return y + u * D_skip[None, None, :]

    def _B_ref(q, k, v, shift_k, ssm_k, ssm_D):
        B, S, D = q.shape
        ks = shift_k.shape[-1]
        k_pad = _pad(k, ((0, 0), (ks - 1, 0), (0, 0)))
        k_shift = torch.zeros_like(k)
        for t in range(ks):
            k_shift = k_shift + k_pad[:, t:t + S, :] * shift_k[:, ks - 1 - t][None, None, :]
        kv = k_shift * v
        L = 2 * S
        kv_pad = _pad(kv, ((0, 0), (0, S), (0, 0)))
        kf_pad = _pad(ssm_k, ((0, 0), (0, S)))
        kv_f = (lambda x, axes=(-2,-1): torch.fft.rfft2(x.float(), dim=axes))(kv_pad[:, None, :, :], axes=(1, 2))
        kf_f = (lambda x, axes=(-2,-1): torch.fft.rfft2(x.float(), dim=axes))(kf_pad[:, None, :], axes=(1, 2))
        kf_f = (lambda x, *d: x.permute(*d))(kf_f, 1, 2, 0)
        y_f = kv_f * kf_f[None, :, :, :]
        y = (lambda x, s, axes=(-2,-1): torch.fft.irfft2(x, s=s, dim=axes).to(torch.bfloat16))(y_f, (1, L), axes=(1, 2))[:, 0, :S, :]
        y = y + kv * ssm_D[None, None, :]
        return q * y

    a = _A_ref(A_u, A_log_A_real, A_A_imag, A_C_real, A_C_imag, A_log_dt, A_D_skip)
    b = _B_ref(B_q, B_k, B_v, B_shift_k, B_ssm_k, B_ssm_D)
    return torch.concatenate([a, b], axis=-1)
```

```asm
; @launch kernel=prep_kernel grid=(2560,1,1) block=(128,1,1) lds=14592
; @launch kernel=conv_kernel grid=(256,1,1) block=(512,1,1) lds=154848
.amdgcn_target "amdgcn-amd-amdhsa--gfx950"
.text
.globl prep_kernel
.p2align 8
.type prep_kernel,@function
prep_kernel:
  s_cmp_lt_u32 s2, 2560
  s_cbranch_scc0 L_k1_end
  s_load_dwordx16 s[8:23], s[0:1], 0
  s_load_dwordx16 s[24:39], s[0:1], 64
  s_waitcnt lgkmcnt(0)
  s_mov_b32 s64, 0xffff0000
  s_mov_b32 s101, 0x05040100
  s_mov_b32 s100, 0x07060302
  s_cmp_lt_u32 s2, 1024
  s_cbranch_scc1 L_kgen
  s_sub_u32 s65, s2, 1024
  s_lshr_b32 s40, s65, 9
  s_and_b32 s41, s65, 511
  s_lshr_b32 s66, s41, 4
  s_and_b32 s67, s41, 15
  s_lshl_b32 s3, s66, 17
  s_lshl_b32 s41, s67, 7
  s_add_u32 s3, s3, s41
  v_lshrrev_b32 v1, 3, v0
  v_and_b32 v2, 7, v0
  v_lshlrev_b32 v3, 13, v1
  v_lshl_add_u32 v3, v2, 4, v3
  v_add_u32 v3, s3, v3
  s_lshl_b32 s3, s40, 22
  s_add_u32 s68, s38, s3
  s_addc_u32 s69, s39, 0
  s_and_b32 s69, s69, 0xffff
  s_mov_b32 s70, 0x400000
  s_mov_b32 s71, 0x00020000
  s_cmp_eq_u32 s40, 1
  s_cbranch_scc1 L_k1_ldkv
  s_cmp_eq_u32 s40, 0
  s_cselect_b32 s72, s8, s22
  s_cselect_b32 s73, s9, s23
  s_and_b32 s73, s73, 0xffff
  s_mov_b32 s74, 0x400000
  s_mov_b32 s75, 0x00020000
  v_add_u32 v4, 0, v3
  buffer_load_dwordx4 v[16:19], v4, s[72:75], 0 offen
  v_add_u32 v4, 2048, v3
  buffer_load_dwordx4 v[20:23], v4, s[72:75], 0 offen
  v_add_u32 v4, 4096, v3
  buffer_load_dwordx4 v[24:27], v4, s[72:75], 0 offen
  v_add_u32 v4, 6144, v3
  buffer_load_dwordx4 v[28:31], v4, s[72:75], 0 offen
  s_waitcnt vmcnt(0)
  s_branch L_k1_st
L_k1_ldkv:
  s_mov_b32 s76, s24
  s_and_b32 s77, s25, 0xffff
  s_mov_b32 s78, 0x400000
  s_mov_b32 s79, 0x00020000
  s_mov_b32 s80, s26
  s_and_b32 s81, s27, 0xffff
  s_mov_b32 s82, 0x400000
  s_mov_b32 s83, 0x00020000
  s_mov_b32 s84, s28
  s_and_b32 s85, s29, 0xffff
  s_mov_b32 s86, 0x2000
  s_mov_b32 s87, 0x00020000
  v_subrev_u32 v4, 6144, v3
  buffer_load_dwordx4 v[32:35], v4, s[76:79], 0 offen
  v_subrev_u32 v4, 4096, v3
  buffer_load_dwordx4 v[36:39], v4, s[76:79], 0 offen
  v_subrev_u32 v4, 2048, v3
  buffer_load_dwordx4 v[40:43], v4, s[76:79], 0 offen
  v_add_u32 v4, 0, v3
  buffer_load_dwordx4 v[44:47], v4, s[76:79], 0 offen
  v_add_u32 v4, 2048, v3
  buffer_load_dwordx4 v[48:51], v4, s[76:79], 0 offen
  v_add_u32 v4, 4096, v3
  buffer_load_dwordx4 v[52:55], v4, s[76:79], 0 offen
  v_add_u32 v4, 6144, v3
  buffer_load_dwordx4 v[56:59], v4, s[76:79], 0 offen
  v_add_u32 v4, 0, v3
  buffer_load_dwordx4 v[60:63], v4, s[80:83], 0 offen
  v_add_u32 v4, 2048, v3
  buffer_load_dwordx4 v[64:67], v4, s[80:83], 0 offen
  v_add_u32 v4, 4096, v3
  buffer_load_dwordx4 v[68:71], v4, s[80:83], 0 offen
  v_add_u32 v4, 6144, v3
  buffer_load_dwordx4 v[72:75], v4, s[80:83], 0 offen
  s_lshl_b32 s3, s67, 9
  v_lshlrev_b32 v5, 6, v2
  v_add_u32 v5, s3, v5
  buffer_load_dwordx4 v[76:79], v5, s[84:87], 0 offen offset:0
  buffer_load_dwordx4 v[80:83], v5, s[84:87], 0 offen offset:16
  buffer_load_dwordx4 v[84:87], v5, s[84:87], 0 offen offset:32
  buffer_load_dwordx4 v[88:91], v5, s[84:87], 0 offen offset:48
  s_waitcnt vmcnt(0)
  v_lshlrev_b32 v112, 16, v76
  v_and_b32 v114, s64, v76
  v_lshlrev_b32 v116, 16, v77
  v_and_b32 v118, s64, v77
  v_lshlrev_b32 v113, 16, v78
  v_and_b32 v115, s64, v78
  v_lshlrev_b32 v117, 16, v79
  v_and_b32 v119, s64, v79
  v_lshlrev_b32 v96, 16, v32
  v_and_b32 v97, s64, v32
  v_lshlrev_b32 v98, 16, v36
  v_and_b32 v99, s64, v36
  v_lshlrev_b32 v100, 16, v40
  v_and_b32 v101, s64, v40
  v_lshlrev_b32 v102, 16, v44
  v_and_b32 v103, s64, v44
  v_lshlrev_b32 v104, 16, v48
  v_and_b32 v105, s64, v48
  v_lshlrev_b32 v106, 16, v52
  v_and_b32 v107, s64, v52
  v_lshlrev_b32 v108, 16, v56
  v_and_b32 v109, s64, v56
  v_pk_mul_f32 v[122:123], v[96:97], v[118:119]
  v_cvt_pk_bf16_f32 v126, v122, v123
  v_lshlrev_b32 v122, 16, v126
  v_and_b32 v123, s64, v126
  v_pk_mul_f32 v[124:125], v[98:99], v[116:117]
  v_cvt_pk_bf16_f32 v126, v124, v125
  v_lshlrev_b32 v124, 16, v126
  v_and_b32 v125, s64, v126
  v_pk_add_f32 v[122:123], v[122:123], v[124:125]
  v_cvt_pk_bf16_f32 v126, v122, v123
  v_lshlrev_b32 v122, 16, v126
  v_and_b32 v123, s64, v126
  v_pk_mul_f32 v[124:125], v[100:101], v[114:115]
  v_cvt_pk_bf16_f32 v126, v124, v125
  v_lshlrev_b32 v124, 16, v126
  v_and_b32 v125, s64, v126
  v_pk_add_f32 v[122:123], v[122:123], v[124:125]
  v_cvt_pk_bf16_f32 v126, v122, v123
  v_lshlrev_b32 v122, 16, v126
  v_and_b32 v123, s64, v126
  v_pk_mul_f32 v[124:125], v[102:103], v[112:113]
  v_cvt_pk_bf16_f32 v126, v124, v125
  v_lshlrev_b32 v124, 16, v126
  v_and_b32 v125, s64, v126
  v_pk_add_f32 v[122:123], v[122:123], v[124:125]
  v_cvt_pk_bf16_f32 v126, v122, v123
  v_lshlrev_b32 v122, 16, v126
  v_and_b32 v123, s64, v126
  v_lshlrev_b32 v120, 16, v60
  v_and_b32 v121, s64, v60
  v_pk_mul_f32 v[122:123], v[122:123], v[120:121]
  v_cvt_pk_bf16_f32 v16, v122, v123
  v_pk_mul_f32 v[122:123], v[98:99], v[118:119]
  v_cvt_pk_bf16_f32 v126, v122, v123
  v_lshlrev_b32 v122, 16, v126
  v_and_b32 v123, s64, v126
  v_pk_mul_f32 v[124:125], v[100:101], v[116:117]
  v_cvt_pk_bf16_f32 v126, v124, v125
  v_lshlrev_b32 v124, 16, v126
  v_and_b32 v125, s64, v126
  v_pk_add_f32 v[122:123], v[122:123], v[124:125]
  v_cvt_pk_bf16_f32 v126, v122, v123
  v_lshlrev_b32 v122, 16, v126
  v_and_b32 v123, s64, v126
  v_pk_mul_f32 v[124:125], v[102:103], v[114:115]
  v_cvt_pk_bf16_f32 v126, v124, v125
  v_lshlrev_b32 v124, 16, v126
  v_and_b32 v125, s64, v126
  v_pk_add_f32 v[122:123], v[122:123], v[124:125]
  v_cvt_pk_bf16_f32 v126, v122, v123
  v_lshlrev_b32 v122, 16, v126
  v_and_b32 v123, s64, v126
  v_pk_mul_f32 v[124:125], v[104:105], v[112:113]
  v_cvt_pk_bf16_f32 v126, v124, v125
  v_lshlrev_b32 v124, 16, v126
  v_and_b32 v125, s64, v126
  v_pk_add_f32 v[122:123], v[122:123], v[124:125]
  v_cvt_pk_bf16_f32 v126, v122, v123
  v_lshlrev_b32 v122, 16, v126
  v_and_b32 v123, s64, v126
  v_lshlrev_b32 v120, 16, v64
  v_and_b32 v121, s64, v64
  v_pk_mul_f32 v[122:123], v[122:123], v[120:121]
  v_cvt_pk_bf16_f32 v20, v122, v123
  v_pk_mul_f32 v[122:123], v[100:101], v[118:119]
  v_cvt_pk_bf16_f32 v126, v122, v123
  v_lshlrev_b32 v122, 16, v126
  v_and_b32 v123, s64, v126
  v_pk_mul_f32 v[124:125], v[102:103], v[116:117]
  v_cvt_pk_bf16_f32 v126, v124, v125
  v_lshlrev_b32 v124, 16, v126
  v_and_b32 v125, s64, v126
  v_pk_add_f32 v[122:123], v[122:123], v[124:125]
  v_cvt_pk_bf16_f32 v126, v122, v123
  v_lshlrev_b32 v122, 16, v126
  v_and_b32 v123, s64, v126
  v_pk_mul_f32 v[124:125], v[104:105], v[114:115]
  v_cvt_pk_bf16_f32 v126, v124, v125
  v_lshlrev_b32 v124, 16, v126
  v_and_b32 v125, s64, v126
  v_pk_add_f32 v[122:123], v[122:123], v[124:125]
  v_cvt_pk_bf16_f32 v126, v122, v123
  v_lshlrev_b32 v122, 16, v126
  v_and_b32 v123, s64, v126
  v_pk_mul_f32 v[124:125], v[106:107], v[112:113]
  v_cvt_pk_bf16_f32 v126, v124, v125
  v_lshlrev_b32 v124, 16, v126
  v_and_b32 v125, s64, v126
  v_pk_add_f32 v[122:123], v[122:123], v[124:125]
  v_cvt_pk_bf16_f32 v126, v122, v123
  v_lshlrev_b32 v122, 16, v126
  v_and_b32 v123, s64, v126
  v_lshlrev_b32 v120, 16, v68
  v_and_b32 v121, s64, v68
  v_pk_mul_f32 v[122:123], v[122:123], v[120:121]
  v_cvt_pk_bf16_f32 v24, v122, v123
  v_pk_mul_f32 v[122:123], v[102:103], v[118:119]
  v_cvt_pk_bf16_f32 v126, v122, v123
  v_lshlrev_b32 v122, 16, v126
  v_and_b32 v123, s64, v126
  v_pk_mul_f32 v[124:125], v[104:105], v[116:117]
  v_cvt_pk_bf16_f32 v126, v124, v125
  v_lshlrev_b32 v124, 16, v126
  v_and_b32 v125, s64, v126
  v_pk_add_f32 v[122:123], v[122:123], v[124:125]
  v_cvt_pk_bf16_f32 v126, v122, v123
  v_lshlrev_b32 v122, 16, v126
  v_and_b32 v123, s64, v126
  v_pk_mul_f32 v[124:125], v[106:107], v[114:115]
  v_cvt_pk_bf16_f32 v126, v124, v125
  v_lshlrev_b32 v124, 16, v126
  v_and_b32 v125, s64, v126
  v_pk_add_f32 v[122:123], v[122:123], v[124:125]
  v_cvt_pk_bf16_f32 v126, v122, v123
  v_lshlrev_b32 v122, 16, v126
  v_and_b32 v123, s64, v126
  v_pk_mul_f32 v[124:125], v[108:109], v[112:113]
  v_cvt_pk_bf16_f32 v126, v124, v125
  v_lshlrev_b32 v124, 16, v126
  v_and_b32 v125, s64, v126
  v_pk_add_f32 v[122:123], v[122:123], v[124:125]
  v_cvt_pk_bf16_f32 v126, v122, v123
  v_lshlrev_b32 v122, 16, v126
  v_and_b32 v123, s64, v126
  v_lshlrev_b32 v120, 16, v72
  v_and_b32 v121, s64, v72
  v_pk_mul_f32 v[122:123], v[122:123], v[120:121]
  v_cvt_pk_bf16_f32 v28, v122, v123
  v_lshlrev_b32 v112, 16, v80
  v_and_b32 v114, s64, v80
  v_lshlrev_b32 v116, 16, v81
  v_and_b32 v118, s64, v81
  v_lshlrev_b32 v113, 16, v82
  v_and_b32 v115, s64, v82
  v_lshlrev_b32 v117, 16, v83
  v_and_b32 v119, s64, v83
  v_lshlrev_b32 v96, 16, v33
  v_and_b32 v97, s64, v33
  v_lshlrev_b32 v98, 16, v37
  v_and_b32 v99, s64, v37
  v_lshlrev_b32 v100, 16, v41
  v_and_b32 v101, s64, v41
  v_lshlrev_b32 v102, 16, v45
  v_and_b32 v103, s64, v45
  v_lshlrev_b32 v104, 16, v49
  v_and_b32 v105, s64, v49
  v_lshlrev_b32 v106, 16, v53
  v_and_b32 v107, s64, v53
  v_lshlrev_b32 v108, 16, v57
  v_and_b32 v109, s64, v57
  v_pk_mul_f32 v[122:123], v[96:97], v[118:119]
  v_cvt_pk_bf16_f32 v126, v122, v123
  v_lshlrev_b32 v122, 16, v126
  v_and_b32 v123, s64, v126
  v_pk_mul_f32 v[124:125], v[98:99], v[116:117]
  v_cvt_pk_bf16_f32 v126, v124, v125
  v_lshlrev_b32 v124, 16, v126
  v_and_b32 v125, s64, v126
  v_pk_add_f32 v[122:123], v[122:123], v[124:125]
  v_cvt_pk_bf16_f32 v126, v122, v123
  v_lshlrev_b32 v122, 16, v126
  v_and_b32 v123, s64, v126
  v_pk_mul_f32 v[124:125], v[100:101], v[114:115]
  v_cvt_pk_bf16_f32 v126, v124, v125
  v_lshlrev_b32 v124, 16, v126
  v_and_b32 v125, s64, v126
  v_pk_add_f32 v[122:123], v[122:123], v[124:125]
  v_cvt_pk_bf16_f32 v126, v122, v123
  v_lshlrev_b32 v122, 16, v126
  v_and_b32 v123, s64, v126
  v_pk_mul_f32 v[124:125], v[102:103], v[112:113]
  v_cvt_pk_bf16_f32 v126, v124, v125
  v_lshlrev_b32 v124, 16, v126
  v_and_b32 v125, s64, v126
  v_pk_add_f32 v[122:123], v[122:123], v[124:125]
  v_cvt_pk_bf16_f32 v126, v122, v123
  v_lshlrev_b32 v122, 16, v126
  v_and_b32 v123, s64, v126
  v_lshlrev_b32 v120, 16, v61
  v_and_b32 v121, s64, v61
  v_pk_mul_f32 v[122:123], v[122:123], v[120:121]
  v_cvt_pk_bf16_f32 v17, v122, v123
  v_pk_mul_f32 v[122:123], v[98:99], v[118:119]
  v_cvt_pk_bf16_f32 v126, v122, v123
  v_lshlrev_b32 v122, 16, v126
  v_and_b32 v123, s64, v126
  v_pk_mul_f32 v[124:125], v[100:101], v[116:117]
  v_cvt_pk_bf16_f32 v126, v124, v125
  v_lshlrev_b32 v124, 16, v126
  v_and_b32 v125, s64, v126
  v_pk_add_f32 v[122:123], v[122:123], v[124:125]
  v_cvt_pk_bf16_f32 v126, v122, v123
  v_lshlrev_b32 v122, 16, v126
  v_and_b32 v123, s64, v126
  v_pk_mul_f32 v[124:125], v[102:103], v[114:115]
  v_cvt_pk_bf16_f32 v126, v124, v125
  v_lshlrev_b32 v124, 16, v126
  v_and_b32 v125, s64, v126
  v_pk_add_f32 v[122:123], v[122:123], v[124:125]
  v_cvt_pk_bf16_f32 v126, v122, v123
  v_lshlrev_b32 v122, 16, v126
  v_and_b32 v123, s64, v126
  v_pk_mul_f32 v[124:125], v[104:105], v[112:113]
  v_cvt_pk_bf16_f32 v126, v124, v125
  v_lshlrev_b32 v124, 16, v126
  v_and_b32 v125, s64, v126
  v_pk_add_f32 v[122:123], v[122:123], v[124:125]
  v_cvt_pk_bf16_f32 v126, v122, v123
  v_lshlrev_b32 v122, 16, v126
  v_and_b32 v123, s64, v126
  v_lshlrev_b32 v120, 16, v65
  v_and_b32 v121, s64, v65
  v_pk_mul_f32 v[122:123], v[122:123], v[120:121]
  v_cvt_pk_bf16_f32 v21, v122, v123
  v_pk_mul_f32 v[122:123], v[100:101], v[118:119]
  v_cvt_pk_bf16_f32 v126, v122, v123
  v_lshlrev_b32 v122, 16, v126
  v_and_b32 v123, s64, v126
  v_pk_mul_f32 v[124:125], v[102:103], v[116:117]
  v_cvt_pk_bf16_f32 v126, v124, v125
  v_lshlrev_b32 v124, 16, v126
  v_and_b32 v125, s64, v126
  v_pk_add_f32 v[122:123], v[122:123], v[124:125]
  v_cvt_pk_bf16_f32 v126, v122, v123
  v_lshlrev_b32 v122, 16, v126
  v_and_b32 v123, s64, v126
  v_pk_mul_f32 v[124:125], v[104:105], v[114:115]
  v_cvt_pk_bf16_f32 v126, v124, v125
  v_lshlrev_b32 v124, 16, v126
  v_and_b32 v125, s64, v126
  v_pk_add_f32 v[122:123], v[122:123], v[124:125]
  v_cvt_pk_bf16_f32 v126, v122, v123
  v_lshlrev_b32 v122, 16, v126
  v_and_b32 v123, s64, v126
  v_pk_mul_f32 v[124:125], v[106:107], v[112:113]
  v_cvt_pk_bf16_f32 v126, v124, v125
  v_lshlrev_b32 v124, 16, v126
  v_and_b32 v125, s64, v126
  v_pk_add_f32 v[122:123], v[122:123], v[124:125]
  v_cvt_pk_bf16_f32 v126, v122, v123
  v_lshlrev_b32 v122, 16, v126
  v_and_b32 v123, s64, v126
  v_lshlrev_b32 v120, 16, v69
  v_and_b32 v121, s64, v69
  v_pk_mul_f32 v[122:123], v[122:123], v[120:121]
  v_cvt_pk_bf16_f32 v25, v122, v123
  v_pk_mul_f32 v[122:123], v[102:103], v[118:119]
  v_cvt_pk_bf16_f32 v126, v122, v123
  v_lshlrev_b32 v122, 16, v126
  v_and_b32 v123, s64, v126
  v_pk_mul_f32 v[124:125], v[104:105], v[116:117]
  v_cvt_pk_bf16_f32 v126, v124, v125
  v_lshlrev_b32 v124, 16, v126
  v_and_b32 v125, s64, v126
  v_pk_add_f32 v[122:123], v[122:123], v[124:125]
  v_cvt_pk_bf16_f32 v126, v122, v123
  v_lshlrev_b32 v122, 16, v126
  v_and_b32 v123, s64, v126
  v_pk_mul_f32 v[124:125], v[106:107], v[114:115]
  v_cvt_pk_bf16_f32 v126, v124, v125
  v_lshlrev_b32 v124, 16, v126
  v_and_b32 v125, s64, v126
  v_pk_add_f32 v[122:123], v[122:123], v[124:125]
  v_cvt_pk_bf16_f32 v126, v122, v123
  v_lshlrev_b32 v122, 16, v126
  v_and_b32 v123, s64, v126
  v_pk_mul_f32 v[124:125], v[108:109], v[112:113]
  v_cvt_pk_bf16_f32 v126, v124, v125
  v_lshlrev_b32 v124, 16, v126
  v_and_b32 v125, s64, v126
  v_pk_add_f32 v[122:123], v[122:123], v[124:125]
  v_cvt_pk_bf16_f32 v126, v122, v123
  v_lshlrev_b32 v122, 16, v126
  v_and_b32 v123, s64, v126
  v_lshlrev_b32 v120, 16, v73
  v_and_b32 v121, s64, v73
  v_pk_mul_f32 v[122:123], v[122:123], v[120:121]
  v_cvt_pk_bf16_f32 v29, v122, v123
  v_lshlrev_b32 v112, 16, v84
  v_and_b32 v114, s64, v84
  v_lshlrev_b32 v116, 16, v85
  v_and_b32 v118, s64, v85
  v_lshlrev_b32 v113, 16, v86
  v_and_b32 v115, s64, v86
  v_lshlrev_b32 v117, 16, v87
  v_and_b32 v119, s64, v87
  v_lshlrev_b32 v96, 16, v34
  v_and_b32 v97, s64, v34
  v_lshlrev_b32 v98, 16, v38
  v_and_b32 v99, s64, v38
  v_lshlrev_b32 v100, 16, v42
  v_and_b32 v101, s64, v42
  v_lshlrev_b32 v102, 16, v46
  v_and_b32 v103, s64, v46
  v_lshlrev_b32 v104, 16, v50
  v_and_b32 v105, s64, v50
  v_lshlrev_b32 v106, 16, v54
  v_and_b32 v107, s64, v54
  v_lshlrev_b32 v108, 16, v58
  v_and_b32 v109, s64, v58
  v_pk_mul_f32 v[122:123], v[96:97], v[118:119]
  v_cvt_pk_bf16_f32 v126, v122, v123
  v_lshlrev_b32 v122, 16, v126
  v_and_b32 v123, s64, v126
  v_pk_mul_f32 v[124:125], v[98:99], v[116:117]
  v_cvt_pk_bf16_f32 v126, v124, v125
  v_lshlrev_b32 v124, 16, v126
  v_and_b32 v125, s64, v126
  v_pk_add_f32 v[122:123], v[122:123], v[124:125]
  v_cvt_pk_bf16_f32 v126, v122, v123
  v_lshlrev_b32 v122, 16, v126
  v_and_b32 v123, s64, v126
  v_pk_mul_f32 v[124:125], v[100:101], v[114:115]
  v_cvt_pk_bf16_f32 v126, v124, v125
  v_lshlrev_b32 v124, 16, v126
  v_and_b32 v125, s64, v126
  v_pk_add_f32 v[122:123], v[122:123], v[124:125]
  v_cvt_pk_bf16_f32 v126, v122, v123
  v_lshlrev_b32 v122, 16, v126
  v_and_b32 v123, s64, v126
  v_pk_mul_f32 v[124:125], v[102:103], v[112:113]
  v_cvt_pk_bf16_f32 v126, v124, v125
  v_lshlrev_b32 v124, 16, v126
  v_and_b32 v125, s64, v126
  v_pk_add_f32 v[122:123], v[122:123], v[124:125]
  v_cvt_pk_bf16_f32 v126, v122, v123
  v_lshlrev_b32 v122, 16, v126
  v_and_b32 v123, s64, v126
  v_lshlrev_b32 v120, 16, v62
  v_and_b32 v121, s64, v62
  v_pk_mul_f32 v[122:123], v[122:123], v[120:121]
  v_cvt_pk_bf16_f32 v18, v122, v123
  v_pk_mul_f32 v[122:123], v[98:99], v[118:119]
  v_cvt_pk_bf16_f32 v126, v122, v123
  v_lshlrev_b32 v122, 16, v126
  v_and_b32 v123, s64, v126
  v_pk_mul_f32 v[124:125], v[100:101], v[116:117]
  v_cvt_pk_bf16_f32 v126, v124, v125
  v_lshlrev_b32 v124, 16, v126
  v_and_b32 v125, s64, v126
  v_pk_add_f32 v[122:123], v[122:123], v[124:125]
  v_cvt_pk_bf16_f32 v126, v122, v123
  v_lshlrev_b32 v122, 16, v126
  v_and_b32 v123, s64, v126
  v_pk_mul_f32 v[124:125], v[102:103], v[114:115]
  v_cvt_pk_bf16_f32 v126, v124, v125
  v_lshlrev_b32 v124, 16, v126
  v_and_b32 v125, s64, v126
  v_pk_add_f32 v[122:123], v[122:123], v[124:125]
  v_cvt_pk_bf16_f32 v126, v122, v123
  v_lshlrev_b32 v122, 16, v126
  v_and_b32 v123, s64, v126
  v_pk_mul_f32 v[124:125], v[104:105], v[112:113]
  v_cvt_pk_bf16_f32 v126, v124, v125
  v_lshlrev_b32 v124, 16, v126
  v_and_b32 v125, s64, v126
  v_pk_add_f32 v[122:123], v[122:123], v[124:125]
  v_cvt_pk_bf16_f32 v126, v122, v123
  v_lshlrev_b32 v122, 16, v126
  v_and_b32 v123, s64, v126
  v_lshlrev_b32 v120, 16, v66
  v_and_b32 v121, s64, v66
  v_pk_mul_f32 v[122:123], v[122:123], v[120:121]
  v_cvt_pk_bf16_f32 v22, v122, v123
  v_pk_mul_f32 v[122:123], v[100:101], v[118:119]
  v_cvt_pk_bf16_f32 v126, v122, v123
  v_lshlrev_b32 v122, 16, v126
  v_and_b32 v123, s64, v126
  v_pk_mul_f32 v[124:125], v[102:103], v[116:117]
  v_cvt_pk_bf16_f32 v126, v124, v125
  v_lshlrev_b32 v124, 16, v126
  v_and_b32 v125, s64, v126
  v_pk_add_f32 v[122:123], v[122:123], v[124:125]
  v_cvt_pk_bf16_f32 v126, v122, v123
  v_lshlrev_b32 v122, 16, v126
  v_and_b32 v123, s64, v126
  v_pk_mul_f32 v[124:125], v[104:105], v[114:115]
  v_cvt_pk_bf16_f32 v126, v124, v125
  v_lshlrev_b32 v124, 16, v126
  v_and_b32 v125, s64, v126
  v_pk_add_f32 v[122:123], v[122:123], v[124:125]
  v_cvt_pk_bf16_f32 v126, v122, v123
  v_lshlrev_b32 v122, 16, v126
  v_and_b32 v123, s64, v126
  v_pk_mul_f32 v[124:125], v[106:107], v[112:113]
  v_cvt_pk_bf16_f32 v126, v124, v125
  v_lshlrev_b32 v124, 16, v126
  v_and_b32 v125, s64, v126
  v_pk_add_f32 v[122:123], v[122:123], v[124:125]
  v_cvt_pk_bf16_f32 v126, v122, v123
  v_lshlrev_b32 v122, 16, v126
  v_and_b32 v123, s64, v126
  v_lshlrev_b32 v120, 16, v70
  v_and_b32 v121, s64, v70
  v_pk_mul_f32 v[122:123], v[122:123], v[120:121]
  v_cvt_pk_bf16_f32 v26, v122, v123
  v_pk_mul_f32 v[122:123], v[102:103], v[118:119]
  v_cvt_pk_bf16_f32 v126, v122, v123
  v_lshlrev_b32 v122, 16, v126
  v_and_b32 v123, s64, v126
  v_pk_mul_f32 v[124:125], v[104:105], v[116:117]
  v_cvt_pk_bf16_f32 v126, v124, v125
  v_lshlrev_b32 v124, 16, v126
  v_and_b32 v125, s64, v126
  v_pk_add_f32 v[122:123], v[122:123], v[124:125]
  v_cvt_pk_bf16_f32 v126, v122, v123
  v_lshlrev_b32 v122, 16, v126
  v_and_b32 v123, s64, v126
  v_pk_mul_f32 v[124:125], v[106:107], v[114:115]
  v_cvt_pk_bf16_f32 v126, v124, v125
  v_lshlrev_b32 v124, 16, v126
  v_and_b32 v125, s64, v126
  v_pk_add_f32 v[122:123], v[122:123], v[124:125]
  v_cvt_pk_bf16_f32 v126, v122, v123
  v_lshlrev_b32 v122, 16, v126
  v_and_b32 v123, s64, v126
  v_pk_mul_f32 v[124:125], v[108:109], v[112:113]
  v_cvt_pk_bf16_f32 v126, v124, v125
  v_lshlrev_b32 v124, 16, v126
  v_and_b32 v125, s64, v126
  v_pk_add_f32 v[122:123], v[122:123], v[124:125]
  v_cvt_pk_bf16_f32 v126, v122, v123
  v_lshlrev_b32 v122, 16, v126
  v_and_b32 v123, s64, v126
  v_lshlrev_b32 v120, 16, v74
  v_and_b32 v121, s64, v74
  v_pk_mul_f32 v[122:123], v[122:123], v[120:121]
  v_cvt_pk_bf16_f32 v30, v122, v123
  v_lshlrev_b32 v112, 16, v88
  v_and_b32 v114, s64, v88
  v_lshlrev_b32 v116, 16, v89
  v_and_b32 v118, s64, v89
  v_lshlrev_b32 v113, 16, v90
  v_and_b32 v115, s64, v90
  v_lshlrev_b32 v117, 16, v91
  v_and_b32 v119, s64, v91
  v_lshlrev_b32 v96, 16, v35
  v_and_b32 v97, s64, v35
  v_lshlrev_b32 v98, 16, v39
  v_and_b32 v99, s64, v39
  v_lshlrev_b32 v100, 16, v43
  v_and_b32 v101, s64, v43
  v_lshlrev_b32 v102, 16, v47
  v_and_b32 v103, s64, v47
  v_lshlrev_b32 v104, 16, v51
  v_and_b32 v105, s64, v51
  v_lshlrev_b32 v106, 16, v55
  v_and_b32 v107, s64, v55
  v_lshlrev_b32 v108, 16, v59
  v_and_b32 v109, s64, v59
  v_pk_mul_f32 v[122:123], v[96:97], v[118:119]
  v_cvt_pk_bf16_f32 v126, v122, v123
  v_lshlrev_b32 v122, 16, v126
  v_and_b32 v123, s64, v126
  v_pk_mul_f32 v[124:125], v[98:99], v[116:117]
  v_cvt_pk_bf16_f32 v126, v124, v125
  v_lshlrev_b32 v124, 16, v126
  v_and_b32 v125, s64, v126
  v_pk_add_f32 v[122:123], v[122:123], v[124:125]
  v_cvt_pk_bf16_f32 v126, v122, v123
  v_lshlrev_b32 v122, 16, v126
  v_and_b32 v123, s64, v126
  v_pk_mul_f32 v[124:125], v[100:101], v[114:115]
  v_cvt_pk_bf16_f32 v126, v124, v125
  v_lshlrev_b32 v124, 16, v126
  v_and_b32 v125, s64, v126
  v_pk_add_f32 v[122:123], v[122:123], v[124:125]
  v_cvt_pk_bf16_f32 v126, v122, v123
  v_lshlrev_b32 v122, 16, v126
  v_and_b32 v123, s64, v126
  v_pk_mul_f32 v[124:125], v[102:103], v[112:113]
  v_cvt_pk_bf16_f32 v126, v124, v125
  v_lshlrev_b32 v124, 16, v126
  v_and_b32 v125, s64, v126
  v_pk_add_f32 v[122:123], v[122:123], v[124:125]
  v_cvt_pk_bf16_f32 v126, v122, v123
  v_lshlrev_b32 v122, 16, v126
  v_and_b32 v123, s64, v126
  v_lshlrev_b32 v120, 16, v63
  v_and_b32 v121, s64, v63
  v_pk_mul_f32 v[122:123], v[122:123], v[120:121]
  v_cvt_pk_bf16_f32 v19, v122, v123
  v_pk_mul_f32 v[122:123], v[98:99], v[118:119]
  v_cvt_pk_bf16_f32 v126, v122, v123
  v_lshlrev_b32 v122, 16, v126
  v_and_b32 v123, s64, v126
  v_pk_mul_f32 v[124:125], v[100:101], v[116:117]
  v_cvt_pk_bf16_f32 v126, v124, v125
  v_lshlrev_b32 v124, 16, v126
  v_and_b32 v125, s64, v126
  v_pk_add_f32 v[122:123], v[122:123], v[124:125]
  v_cvt_pk_bf16_f32 v126, v122, v123
  v_lshlrev_b32 v122, 16, v126
  v_and_b32 v123, s64, v126
  v_pk_mul_f32 v[124:125], v[102:103], v[114:115]
  v_cvt_pk_bf16_f32 v126, v124, v125
  v_lshlrev_b32 v124, 16, v126
  v_and_b32 v125, s64, v126
  v_pk_add_f32 v[122:123], v[122:123], v[124:125]
  v_cvt_pk_bf16_f32 v126, v122, v123
  v_lshlrev_b32 v122, 16, v126
  v_and_b32 v123, s64, v126
  v_pk_mul_f32 v[124:125], v[104:105], v[112:113]
  v_cvt_pk_bf16_f32 v126, v124, v125
  v_lshlrev_b32 v124, 16, v126
  v_and_b32 v125, s64, v126
  v_pk_add_f32 v[122:123], v[122:123], v[124:125]
  v_cvt_pk_bf16_f32 v126, v122, v123
  v_lshlrev_b32 v122, 16, v126
  v_and_b32 v123, s64, v126
  v_lshlrev_b32 v120, 16, v67
  v_and_b32 v121, s64, v67
  v_pk_mul_f32 v[122:123], v[122:123], v[120:121]
  v_cvt_pk_bf16_f32 v23, v122, v123
  v_pk_mul_f32 v[122:123], v[100:101], v[118:119]
  v_cvt_pk_bf16_f32 v126, v122, v123
  v_lshlrev_b32 v122, 16, v126
  v_and_b32 v123, s64, v126
  v_pk_mul_f32 v[124:125], v[102:103], v[116:117]
  v_cvt_pk_bf16_f32 v126, v124, v125
  v_lshlrev_b32 v124, 16, v126
  v_and_b32 v125, s64, v126
  v_pk_add_f32 v[122:123], v[122:123], v[124:125]
  v_cvt_pk_bf16_f32 v126, v122, v123
  v_lshlrev_b32 v122, 16, v126
  v_and_b32 v123, s64, v126
  v_pk_mul_f32 v[124:125], v[104:105], v[114:115]
  v_cvt_pk_bf16_f32 v126, v124, v125
  v_lshlrev_b32 v124, 16, v126
  v_and_b32 v125, s64, v126
  v_pk_add_f32 v[122:123], v[122:123], v[124:125]
  v_cvt_pk_bf16_f32 v126, v122, v123
  v_lshlrev_b32 v122, 16, v126
  v_and_b32 v123, s64, v126
  v_pk_mul_f32 v[124:125], v[106:107], v[112:113]
  v_cvt_pk_bf16_f32 v126, v124, v125
  v_lshlrev_b32 v124, 16, v126
  v_and_b32 v125, s64, v126
  v_pk_add_f32 v[122:123], v[122:123], v[124:125]
  v_cvt_pk_bf16_f32 v126, v122, v123
  v_lshlrev_b32 v122, 16, v126
  v_and_b32 v123, s64, v126
  v_lshlrev_b32 v120, 16, v71
  v_and_b32 v121, s64, v71
  v_pk_mul_f32 v[122:123], v[122:123], v[120:121]
  v_cvt_pk_bf16_f32 v27, v122, v123
  v_pk_mul_f32 v[122:123], v[102:103], v[118:119]
  v_cvt_pk_bf16_f32 v126, v122, v123
  v_lshlrev_b32 v122, 16, v126
  v_and_b32 v123, s64, v126
  v_pk_mul_f32 v[124:125], v[104:105], v[116:117]
  v_cvt_pk_bf16_f32 v126, v124, v125
  v_lshlrev_b32 v124, 16, v126
  v_and_b32 v125, s64, v126
  v_pk_add_f32 v[122:123], v[122:123], v[124:125]
  v_cvt_pk_bf16_f32 v126, v122, v123
  v_lshlrev_b32 v122, 16, v126
  v_and_b32 v123, s64, v126
  v_pk_mul_f32 v[124:125], v[106:107], v[114:115]
  v_cvt_pk_bf16_f32 v126, v124, v125
  v_lshlrev_b32 v124, 16, v126
  v_and_b32 v125, s64, v126
  v_pk_add_f32 v[122:123], v[122:123], v[124:125]
  v_cvt_pk_bf16_f32 v126, v122, v123
  v_lshlrev_b32 v122, 16, v126
  v_and_b32 v123, s64, v126
  v_pk_mul_f32 v[124:125], v[108:109], v[112:113]
  v_cvt_pk_bf16_f32 v126, v124, v125
  v_lshlrev_b32 v124, 16, v126
  v_and_b32 v125, s64, v126
  v_pk_add_f32 v[122:123], v[122:123], v[124:125]
  v_cvt_pk_bf16_f32 v126, v122, v123
  v_lshlrev_b32 v122, 16, v126
  v_and_b32 v123, s64, v126
  v_lshlrev_b32 v120, 16, v75
  v_and_b32 v121, s64, v75
  v_pk_mul_f32 v[122:123], v[122:123], v[120:121]
  v_cvt_pk_bf16_f32 v31, v122, v123
L_k1_st:
  v_lshrrev_b32 v1, 3, v0
  v_and_b32 v2, 7, v0
  v_mul_u32_u24 v6, 1152, v2
  v_lshl_add_u32 v6, v1, 3, v6
  v_perm_b32 v8, v20, v16, s101
  v_perm_b32 v9, v28, v24, s101
  v_perm_b32 v10, v20, v16, s100
  v_perm_b32 v11, v28, v24, s100
  ds_write_b64 v6, v[8:9] offset:0
  ds_write_b64 v6, v[10:11] offset:144
  v_perm_b32 v12, v21, v17, s101
  v_perm_b32 v13, v29, v25, s101
  v_perm_b32 v14, v21, v17, s100
  v_perm_b32 v15, v29, v25, s100
  ds_write_b64 v6, v[12:13] offset:288
  ds_write_b64 v6, v[14:15] offset:432
  v_perm_b32 v8, v22, v18, s101
  v_perm_b32 v9, v30, v26, s101
  v_perm_b32 v10, v22, v18, s100
  v_perm_b32 v11, v30, v26, s100
  ds_write_b64 v6, v[8:9] offset:576
  ds_write_b64 v6, v[10:11] offset:720
  v_perm_b32 v12, v23, v19, s101
  v_perm_b32 v13, v31, v27, s101
  v_perm_b32 v14, v23, v19, s100
  v_perm_b32 v15, v31, v27, s100
  ds_write_b64 v6, v[12:13] offset:864
  ds_write_b64 v6, v[14:15] offset:1008
  s_waitcnt lgkmcnt(0)
  s_barrier
  v_mul_u32_u24 v6, 144, v1
  v_lshl_add_u32 v6, v2, 4, v6
  ds_read_b128 v[16:19], v6 offset:0
  ds_read_b128 v[20:23], v6 offset:2304
  ds_read_b128 v[24:27], v6 offset:4608
  ds_read_b128 v[28:31], v6 offset:6912
  s_lshl_b32 s3, s67, 18
  s_lshl_b32 s41, s66, 7
  s_add_u32 s3, s3, s41
  v_lshlrev_b32 v7, 12, v1
  v_lshl_add_u32 v7, v2, 4, v7
  v_add_u32 v7, s3, v7
  s_waitcnt lgkmcnt(3)
  v_add_u32 v4, 0x0, v7
  buffer_store_dwordx4 v[16:19], v4, s[68:71], 0 offen
  s_waitcnt lgkmcnt(2)
  v_add_u32 v4, 0x10000, v7
  buffer_store_dwordx4 v[20:23], v4, s[68:71], 0 offen
  s_waitcnt lgkmcnt(1)
  v_add_u32 v4, 0x20000, v7
  buffer_store_dwordx4 v[24:27], v4, s[68:71], 0 offen
  s_waitcnt lgkmcnt(0)
  v_add_u32 v4, 0x30000, v7
  buffer_store_dwordx4 v[28:31], v4, s[68:71], 0 offen
  s_barrier
  s_branch L_k1_end
L_kgen:
  s_mov_b32 s40, s10
  s_and_b32 s41, s11, 0xffff
  s_mov_b32 s42, 0x40000
  s_mov_b32 s43, 0x00020000
  s_mov_b32 s44, s12
  s_and_b32 s45, s13, 0xffff
  s_mov_b32 s46, 0x40000
  s_mov_b32 s47, 0x00020000
  s_mov_b32 s48, s14
  s_and_b32 s49, s15, 0xffff
  s_mov_b32 s50, 0x40000
  s_mov_b32 s51, 0x00020000
  s_mov_b32 s52, s16
  s_and_b32 s53, s17, 0xffff
  s_mov_b32 s54, 0x40000
  s_mov_b32 s55, 0x00020000
  s_mov_b32 s56, s18
  s_and_b32 s57, s19, 0xffff
  s_mov_b32 s58, 0x800
  s_mov_b32 s59, 0x00020000
  s_add_u32 s60, s38, 0xc00000
  s_addc_u32 s61, s39, 0
  s_and_b32 s61, s61, 0xffff
  s_mov_b32 s62, 0x400000
  s_mov_b32 s63, 0x00020000
  v_and_b32 v8, 63, v0
  v_lshrrev_b32 v9, 6, v0
  v_mul_u32_u24 v10, 4160, v9
  v_and_b32 v12, 15, v8
  v_lshrrev_b32 v13, 4, v8
  s_lshl_b32 s3, s2, 8
  v_lshlrev_b32 v1, 1, v0
  v_add_u32 v1, s3, v1
  s_lshl_b32 s3, s2, 1
  v_mov_b32 v2, s3
  buffer_load_ushort v3, v1, s[40:43], 0 offen
  buffer_load_ushort v4, v1, s[44:47], 0 offen
  buffer_load_ushort v5, v1, s[48:51], 0 offen
  buffer_load_ushort v6, v1, s[52:55], 0 offen
  buffer_load_ushort v7, v2, s[56:59], 0 offen
  v_cvt_f32_u32 v14, v12
  s_waitcnt vmcnt(0)
  v_lshlrev_b32 v3, 16, v3
  v_lshlrev_b32 v4, 16, v4
  v_lshlrev_b32 v5, 16, v5
  v_lshlrev_b32 v6, 16, v6
  v_lshlrev_b32 v7, 16, v7
  v_mul_f32 v7, 0x3fb8aa3b, v7
  v_mul_f32 v3, 0x3fb8aa3b, v3
  v_exp_f32 v7, v7
  v_exp_f32 v3, v3
  s_nop 0
  v_cvt_pk_bf16_f32 v15, v7, v3
  v_lshlrev_b32 v7, 16, v15
  v_and_b32 v3, s64, v15
  v_mul_f32 v20, v3, v7
  v_mul_f32 v21, v4, v7
  v_mov_b32 v22, 0
  v_mov_b32 v23, 0
  v_mul_f32 v24, v5, v7
  v_mul_f32 v25, v6, v7
  v_add_f32 v24, v24, v24
  v_add_f32 v25, v25, v25
  v_max_f32 v36, abs(v24), abs(v25)
  ds_swizzle_b32 v37, v36 offset:0x041F
  s_waitcnt lgkmcnt(0)
  v_max_f32 v36, v36, v37
  ds_swizzle_b32 v37, v36 offset:0x081F
  s_waitcnt lgkmcnt(0)
  v_max_f32 v36, v36, v37
  ds_swizzle_b32 v37, v36 offset:0x101F
  s_waitcnt lgkmcnt(0)
  v_max_f32 v36, v36, v37
  ds_swizzle_b32 v37, v36 offset:0x201F
  s_waitcnt lgkmcnt(0)
  v_max_f32 v36, v36, v37
  ds_swizzle_b32 v37, v36 offset:0x401F
  s_waitcnt lgkmcnt(0)
  v_max_f32 v36, v36, v37
  s_nop 0
  v_readlane_b32 s66, v36, 0
  v_readlane_b32 s67, v36, 32
  s_nop 1
  s_max_u32 s66, s66, s67
  s_and_b32 s66, s66, 0x7f800000
  s_sub_u32 s67, 0x7f000000, s66
  v_mul_f32 v24, s67, v24
  v_mul_f32 v25, s67, v25
  v_mul_f32 v32, 0x43800000, v20
  v_mul_f32 v33, 0x43800000, v21
  v_mul_f32 v32, 0xbfb8aa3b, v32
  v_mul_f32 v33, 0x3e22f983, v33
  v_exp_f32 v32, v32
  v_fract_f32 v33, v33
  v_cos_f32 v26, v33
  v_sin_f32 v27, v33
  s_nop 0
  v_pk_mul_f32 v[26:27], v[26:27], v[32:33] op_sel_hi:[1,0]
  v_pk_mul_f32 v[34:35], v[26:27], v[24:25] op_sel:[1,1] op_sel_hi:[1,0]
  v_pk_fma_f32 v[26:27], v[26:27], v[24:25], v[34:35] op_sel:[0,0,0] op_sel_hi:[0,1,1] neg_lo:[0,0,1]
  v_mul_f32 v32, 0x44000000, v20
  v_mul_f32 v33, 0x44000000, v21
  v_mul_f32 v32, 0xbfb8aa3b, v32
  v_mul_f32 v33, 0x3e22f983, v33
  v_exp_f32 v32, v32
  v_fract_f32 v33, v33
  v_cos_f32 v28, v33
  v_sin_f32 v29, v33
  s_nop 0
  v_pk_mul_f32 v[28:29], v[28:29], v[32:33] op_sel_hi:[1,0]
  v_pk_mul_f32 v[34:35], v[28:29], v[24:25] op_sel:[1,1] op_sel_hi:[1,0]
  v_pk_fma_f32 v[28:29], v[28:29], v[24:25], v[34:35] op_sel:[0,0,0] op_sel_hi:[0,1,1] neg_lo:[0,0,1]
  v_mul_f32 v32, 0x44800000, v20
  v_mul_f32 v33, 0x44800000, v21
  v_mul_f32 v32, 0xbfb8aa3b, v32
  v_mul_f32 v33, 0x3e22f983, v33
  v_exp_f32 v32, v32
  v_fract_f32 v33, v33
  v_cos_f32 v30, v33
  v_sin_f32 v31, v33
  s_nop 0
  v_pk_mul_f32 v[30:31], v[30:31], v[32:33] op_sel_hi:[1,0]
  v_pk_mul_f32 v[34:35], v[30:31], v[24:25] op_sel:[1,1] op_sel_hi:[1,0]
  v_pk_fma_f32 v[30:31], v[30:31], v[24:25], v[34:35] op_sel:[0,0,0] op_sel_hi:[0,1,1] neg_lo:[0,0,1]
  v_mul_u32_u24 v1, 48, v0
  ds_write_b128 v1, v[20:23] offset:8448
  ds_write_b128 v1, v[24:27] offset:8464
  ds_write_b128 v1, v[28:31] offset:8480
  v_lshlrev_b32 v1, 6, v9
  v_lshl_add_u32 v1, v13, 2, v1
  v_mul_u32_u24 v1, 48, v1
  s_waitcnt lgkmcnt(0)
  ds_read_b128 v[20:23], v1 offset:8448
  ds_read_b128 v[24:27], v1 offset:8464
  ds_read_b128 v[28:31], v1 offset:8480
  ds_read_b128 v[44:47], v1 offset:8496
  ds_read_b128 v[48:51], v1 offset:8512
  ds_read_b128 v[52:55], v1 offset:8528
  s_waitcnt lgkmcnt(0)
  v_pk_mul_f32 v[32:33], v[20:21], v[14:15] op_sel_hi:[1,0]
  v_pk_mul_f32 v[56:57], v[44:45], v[14:15] op_sel_hi:[1,0]
  v_mul_f32 v32, 0xbfb8aa3b, v32
  v_mul_f32 v56, 0xbfb8aa3b, v56
  v_mul_f32 v33, 0xbe22f983, v33
  v_mul_f32 v57, 0xbe22f983, v57
  v_exp_f32 v32, v32
  v_exp_f32 v56, v56
  v_fract_f32 v33, v33
  v_fract_f32 v57, v57
  v_cos_f32 v36, v33
  v_cos_f32 v60, v57
  v_sin_f32 v37, v33
  v_sin_f32 v61, v57
  s_nop 0
  s_nop 0
  v_pk_mul_f32 v[36:37], v[36:37], v[32:33] op_sel_hi:[1,0]
  v_pk_mul_f32 v[60:61], v[60:61], v[56:57] op_sel_hi:[1,0]
  v_cvt_pk_f16_f32 v92, v36, v37
  v_cvt_pk_f16_f32 v93, v60, v61
  v_pk_mul_f32 v[34:35], v[36:37], v[36:37] op_sel:[1,1] op_sel_hi:[1,0]
  v_pk_mul_f32 v[58:59], v[60:61], v[60:61] op_sel:[1,1] op_sel_hi:[1,0]
  v_pk_fma_f32 v[36:37], v[36:37], v[36:37], v[34:35] op_sel:[0,0,0] op_sel_hi:[0,1,1] neg_lo:[0,0,1]
  v_pk_fma_f32 v[60:61], v[60:61], v[60:61], v[58:59] op_sel:[0,0,0] op_sel_hi:[0,1,1] neg_lo:[0,0,1]
  v_cvt_pk_f16_f32 v96, v36, v37
  v_cvt_pk_f16_f32 v97, v60, v61
  v_pk_mul_f32 v[34:35], v[36:37], v[36:37] op_sel:[1,1] op_sel_hi:[1,0]
  v_pk_mul_f32 v[58:59], v[60:61], v[60:61] op_sel:[1,1] op_sel_hi:[1,0]
  v_pk_fma_f32 v[36:37], v[36:37], v[36:37], v[34:35] op_sel:[0,0,0] op_sel_hi:[0,1,1] neg_lo:[0,0,1]
  v_pk_fma_f32 v[60:61], v[60:61], v[60:61], v[58:59] op_sel:[0,0,0] op_sel_hi:[0,1,1] neg_lo:[0,0,1]
  v_cvt_pk_f16_f32 v100, v36, v37
  v_cvt_pk_f16_f32 v101, v60, v61
  v_pk_mul_f32 v[34:35], v[36:37], v[36:37] op_sel:[1,1] op_sel_hi:[1,0]
  v_pk_mul_f32 v[58:59], v[60:61], v[60:61] op_sel:[1,1] op_sel_hi:[1,0]
  v_pk_fma_f32 v[36:37], v[36:37], v[36:37], v[34:35] op_sel:[0,0,0] op_sel_hi:[0,1,1] neg_lo:[0,0,1]
  v_pk_fma_f32 v[60:61], v[60:61], v[60:61], v[58:59] op_sel:[0,0,0] op_sel_hi:[0,1,1] neg_lo:[0,0,1]
  v_cvt_pk_f16_f32 v104, v36, v37
  v_cvt_pk_f16_f32 v105, v60, v61
  v_pk_mul_f32 v[34:35], v[36:37], v[36:37] op_sel:[1,1] op_sel_hi:[1,0]
  v_pk_mul_f32 v[58:59], v[60:61], v[60:61] op_sel:[1,1] op_sel_hi:[1,0]
  v_pk_fma_f32 v[38:39], v[36:37], v[36:37], v[34:35] op_sel:[0,0,0] op_sel_hi:[0,1,1] neg_lo:[0,0,1]
  v_pk_fma_f32 v[62:63], v[60:61], v[60:61], v[58:59] op_sel:[0,0,0] op_sel_hi:[0,1,1] neg_lo:[0,0,1]
  v_xor_b32 v39, 0x80000000, v39
  v_xor_b32 v63, 0x80000000, v63
  v_pk_mul_f32 v[34:35], v[38:39], v[24:25] op_sel:[1,1] op_sel_hi:[1,0]
  v_pk_mul_f32 v[58:59], v[62:63], v[48:49] op_sel:[1,1] op_sel_hi:[1,0]
  v_pk_fma_f32 v[40:41], v[38:39], v[24:25], v[34:35] op_sel:[0,0,0] op_sel_hi:[0,1,1] neg_lo:[0,0,1]
  v_pk_fma_f32 v[64:65], v[62:63], v[48:49], v[58:59] op_sel:[0,0,0] op_sel_hi:[0,1,1] neg_lo:[0,0,1]
  v_pk_mul_f32 v[34:35], v[38:39], v[38:39] op_sel:[1,1] op_sel_hi:[1,0]
  v_pk_mul_f32 v[58:59], v[62:63], v[62:63] op_sel:[1,1] op_sel_hi:[1,0]
  v_pk_fma_f32 v[38:39], v[38:39], v[38:39], v[34:35] op_sel:[0,0,0] op_sel_hi:[0,1,1] neg_lo:[0,0,1]
  v_pk_fma_f32 v[62:63], v[62:63], v[62:63], v[58:59] op_sel:[0,0,0] op_sel_hi:[0,1,1] neg_lo:[0,0,1]
  v_cvt_pk_f16_f32 v76, v40, v41
  v_cvt_pk_f16_f32 v77, v64, v65
  v_pk_mul_f32 v[34:35], v[38:39], v[26:27] op_sel:[1,1] op_sel_hi:[1,0]
  v_pk_mul_f32 v[58:59], v[62:63], v[50:51] op_sel:[1,1] op_sel_hi:[1,0]
  v_pk_fma_f32 v[40:41], v[38:39], v[26:27], v[34:35] op_sel:[0,0,0] op_sel_hi:[0,1,1] neg_lo:[0,0,1]
  v_pk_fma_f32 v[64:65], v[62:63], v[50:51], v[58:59] op_sel:[0,0,0] op_sel_hi:[0,1,1] neg_lo:[0,0,1]
  v_pk_mul_f32 v[34:35], v[38:39], v[38:39] op_sel:[1,1] op_sel_hi:[1,0]
  v_pk_mul_f32 v[58:59], v[62:63], v[62:63] op_sel:[1,1] op_sel_hi:[1,0]
  v_pk_fma_f32 v[38:39], v[38:39], v[38:39], v[34:35] op_sel:[0,0,0] op_sel_hi:[0,1,1] neg_lo:[0,0,1]
  v_pk_fma_f32 v[62:63], v[62:63], v[62:63], v[58:59] op_sel:[0,0,0] op_sel_hi:[0,1,1] neg_lo:[0,0,1]
  v_cvt_pk_f16_f32 v80, v40, v41
  v_cvt_pk_f16_f32 v81, v64, v65
  v_pk_mul_f32 v[34:35], v[38:39], v[28:29] op_sel:[1,1] op_sel_hi:[1,0]
  v_pk_mul_f32 v[58:59], v[62:63], v[52:53] op_sel:[1,1] op_sel_hi:[1,0]
  v_pk_fma_f32 v[40:41], v[38:39], v[28:29], v[34:35] op_sel:[0,0,0] op_sel_hi:[0,1,1] neg_lo:[0,0,1]
  v_pk_fma_f32 v[64:65], v[62:63], v[52:53], v[58:59] op_sel:[0,0,0] op_sel_hi:[0,1,1] neg_lo:[0,0,1]
  v_pk_mul_f32 v[34:35], v[38:39], v[38:39] op_sel:[1,1] op_sel_hi:[1,0]
  v_pk_mul_f32 v[58:59], v[62:63], v[62:63] op_sel:[1,1] op_sel_hi:[1,0]
  v_pk_fma_f32 v[38:39], v[38:39], v[38:39], v[34:35] op_sel:[0,0,0] op_sel_hi:[0,1,1] neg_lo:[0,0,1]
  v_pk_fma_f32 v[62:63], v[62:63], v[62:63], v[58:59] op_sel:[0,0,0] op_sel_hi:[0,1,1] neg_lo:[0,0,1]
  v_cvt_pk_f16_f32 v84, v40, v41
  v_cvt_pk_f16_f32 v85, v64, v65
  v_pk_mul_f32 v[34:35], v[38:39], v[30:31] op_sel:[1,1] op_sel_hi:[1,0]
  v_pk_mul_f32 v[58:59], v[62:63], v[54:55] op_sel:[1,1] op_sel_hi:[1,0]
  v_pk_fma_f32 v[40:41], v[38:39], v[30:31], v[34:35] op_sel:[0,0,0] op_sel_hi:[0,1,1] neg_lo:[0,0,1]
  v_pk_fma_f32 v[64:65], v[62:63], v[54:55], v[58:59] op_sel:[0,0,0] op_sel_hi:[0,1,1] neg_lo:[0,0,1]
  v_cvt_pk_f16_f32 v88, v40, v41
  v_cvt_pk_f16_f32 v89, v64, v65
  ds_read_b128 v[20:23], v1 offset:8544
  ds_read_b128 v[24:27], v1 offset:8560
  ds_read_b128 v[28:31], v1 offset:8576
  ds_read_b128 v[44:47], v1 offset:8592
  ds_read_b128 v[48:51], v1 offset:8608
  ds_read_b128 v[52:55], v1 offset:8624
  s_waitcnt lgkmcnt(0)
  v_pk_mul_f32 v[32:33], v[20:21], v[14:15] op_sel_hi:[1,0]
  v_pk_mul_f32 v[56:57], v[44:45], v[14:15] op_sel_hi:[1,0]
  v_mul_f32 v32, 0xbfb8aa3b, v32
  v_mul_f32 v56, 0xbfb8aa3b, v56
  v_mul_f32 v33, 0xbe22f983, v33
  v_mul_f32 v57, 0xbe22f983, v57
  v_exp_f32 v32, v32
  v_exp_f32 v56, v56
  v_fract_f32 v33, v33
  v_fract_f32 v57, v57
  v_cos_f32 v36, v33
  v_cos_f32 v60, v57
  v_sin_f32 v37, v33
  v_sin_f32 v61, v57
  s_nop 0
  s_nop 0
  v_pk_mul_f32 v[36:37], v[36:37], v[32:33] op_sel_hi:[1,0]
  v_pk_mul_f32 v[60:61], v[60:61], v[56:57] op_sel_hi:[1,0]
  v_cvt_pk_f16_f32 v94, v36, v37
  v_cvt_pk_f16_f32 v95, v60, v61
  v_pk_mul_f32 v[34:35], v[36:37], v[36:37] op_sel:[1,1] op_sel_hi:[1,0]
  v_pk_mul_f32 v[58:59], v[60:61], v[60:61] op_sel:[1,1] op_sel_hi:[1,0]
  v_pk_fma_f32 v[36:37], v[36:37], v[36:37], v[34:35] op_sel:[0,0,0] op_sel_hi:[0,1,1] neg_lo:[0,0,1]
  v_pk_fma_f32 v[60:61], v[60:61], v[60:61], v[58:59] op_sel:[0,0,0] op_sel_hi:[0,1,1] neg_lo:[0,0,1]
  v_cvt_pk_f16_f32 v98, v36, v37
  v_cvt_pk_f16_f32 v99, v60, v61
  v_pk_mul_f32 v[34:35], v[36:37], v[36:37] op_sel:[1,1] op_sel_hi:[1,0]
  v_pk_mul_f32 v[58:59], v[60:61], v[60:61] op_sel:[1,1] op_sel_hi:[1,0]
  v_pk_fma_f32 v[36:37], v[36:37], v[36:37], v[34:35] op_sel:[0,0,0] op_sel_hi:[0,1,1] neg_lo:[0,0,1]
  v_pk_fma_f32 v[60:61], v[60:61], v[60:61], v[58:59] op_sel:[0,0,0] op_sel_hi:[0,1,1] neg_lo:[0,0,1]
  v_cvt_pk_f16_f32 v102, v36, v37
  v_cvt_pk_f16_f32 v103, v60, v61
  v_pk_mul_f32 v[34:35], v[36:37], v[36:37] op_sel:[1,1] op_sel_hi:[1,0]
  v_pk_mul_f32 v[58:59], v[60:61], v[60:61] op_sel:[1,1] op_sel_hi:[1,0]
  v_pk_fma_f32 v[36:37], v[36:37], v[36:37], v[34:35] op_sel:[0,0,0] op_sel_hi:[0,1,1] neg_lo:[0,0,1]
  v_pk_fma_f32 v[60:61], v[60:61], v[60:61], v[58:59] op_sel:[0,0,0] op_sel_hi:[0,1,1] neg_lo:[0,0,1]
  v_cvt_pk_f16_f32 v106, v36, v37
  v_cvt_pk_f16_f32 v107, v60, v61
  v_pk_mul_f32 v[34:35], v[36:37], v[36:37] op_sel:[1,1] op_sel_hi:[1,0]
  v_pk_mul_f32 v[58:59], v[60:61], v[60:61] op_sel:[1,1] op_sel_hi:[1,0]
  v_pk_fma_f32 v[38:39], v[36:37], v[36:37], v[34:35] op_sel:[0,0,0] op_sel_hi:[0,1,1] neg_lo:[0,0,1]
  v_pk_fma_f32 v[62:63], v[60:61], v[60:61], v[58:59] op_sel:[0,0,0] op_sel_hi:[0,1,1] neg_lo:[0,0,1]
  v_xor_b32 v39, 0x80000000, v39
  v_xor_b32 v63, 0x80000000, v63
  v_pk_mul_f32 v[34:35], v[38:39], v[24:25] op_sel:[1,1] op_sel_hi:[1,0]
  v_pk_mul_f32 v[58:59], v[62:63], v[48:49] op_sel:[1,1] op_sel_hi:[1,0]
  v_pk_fma_f32 v[40:41], v[38:39], v[24:25], v[34:35] op_sel:[0,0,0] op_sel_hi:[0,1,1] neg_lo:[0,0,1]
  v_pk_fma_f32 v[64:65], v[62:63], v[48:49], v[58:59] op_sel:[0,0,0] op_sel_hi:[0,1,1] neg_lo:[0,0,1]
  v_pk_mul_f32 v[34:35], v[38:39], v[38:39] op_sel:[1,1] op_sel_hi:[1,0]
  v_pk_mul_f32 v[58:59], v[62:63], v[62:63] op_sel:[1,1] op_sel_hi:[1,0]
  v_pk_fma_f32 v[38:39], v[38:39], v[38:39], v[34:35] op_sel:[0,0,0] op_sel_hi:[0,1,1] neg_lo:[0,0,1]
  v_pk_fma_f32 v[62:63], v[62:63], v[62:63], v[58:59] op_sel:[0,0,0] op_sel_hi:[0,1,1] neg_lo:[0,0,1]
  v_cvt_pk_f16_f32 v78, v40, v41
  v_cvt_pk_f16_f32 v79, v64, v65
  v_pk_mul_f32 v[34:35], v[38:39], v[26:27] op_sel:[1,1] op_sel_hi:[1,0]
  v_pk_mul_f32 v[58:59], v[62:63], v[50:51] op_sel:[1,1] op_sel_hi:[1,0]
  v_pk_fma_f32 v[40:41], v[38:39], v[26:27], v[34:35] op_sel:[0,0,0] op_sel_hi:[0,1,1] neg_lo:[0,0,1]
  v_pk_fma_f32 v[64:65], v[62:63], v[50:51], v[58:59] op_sel:[0,0,0] op_sel_hi:[0,1,1] neg_lo:[0,0,1]
  v_pk_mul_f32 v[34:35], v[38:39], v[38:39] op_sel:[1,1] op_sel_hi:[1,0]
  v_pk_mul_f32 v[58:59], v[62:63], v[62:63] op_sel:[1,1] op_sel_hi:[1,0]
  v_pk_fma_f32 v[38:39], v[38:39], v[38:39], v[34:35] op_sel:[0,0,0] op_sel_hi:[0,1,1] neg_lo:[0,0,1]
  v_pk_fma_f32 v[62:63], v[62:63], v[62:63], v[58:59] op_sel:[0,0,0] op_sel_hi:[0,1,1] neg_lo:[0,0,1]
  v_cvt_pk_f16_f32 v82, v40, v41
  v_cvt_pk_f16_f32 v83, v64, v65
  v_pk_mul_f32 v[34:35], v[38:39], v[28:29] op_sel:[1,1] op_sel_hi:[1,0]
  v_pk_mul_f32 v[58:59], v[62:63], v[52:53] op_sel:[1,1] op_sel_hi:[1,0]
  v_pk_fma_f32 v[40:41], v[38:39], v[28:29], v[34:35] op_sel:[0,0,0] op_sel_hi:[0,1,1] neg_lo:[0,0,1]
  v_pk_fma_f32 v[64:65], v[62:63], v[52:53], v[58:59] op_sel:[0,0,0] op_sel_hi:[0,1,1] neg_lo:[0,0,1]
  v_pk_mul_f32 v[34:35], v[38:39], v[38:39] op_sel:[1,1] op_sel_hi:[1,0]
  v_pk_mul_f32 v[58:59], v[62:63], v[62:63] op_sel:[1,1] op_sel_hi:[1,0]
  v_pk_fma_f32 v[38:39], v[38:39], v[38:39], v[34:35] op_sel:[0,0,0] op_sel_hi:[0,1,1] neg_lo:[0,0,1]
  v_pk_fma_f32 v[62:63], v[62:63], v[62:63], v[58:59] op_sel:[0,0,0] op_sel_hi:[0,1,1] neg_lo:[0,0,1]
  v_cvt_pk_f16_f32 v86, v40, v41
  v_cvt_pk_f16_f32 v87, v64, v65
  v_pk_mul_f32 v[34:35], v[38:39], v[30:31] op_sel:[1,1] op_sel_hi:[1,0]
  v_pk_mul_f32 v[58:59], v[62:63], v[54:55] op_sel:[1,1] op_sel_hi:[1,0]
  v_pk_fma_f32 v[40:41], v[38:39], v[30:31], v[34:35] op_sel:[0,0,0] op_sel_hi:[0,1,1] neg_lo:[0,0,1]
  v_pk_fma_f32 v[64:65], v[62:63], v[54:55], v[58:59] op_sel:[0,0,0] op_sel_hi:[0,1,1] neg_lo:[0,0,1]
  v_cvt_pk_f16_f32 v90, v40, v41
  v_cvt_pk_f16_f32 v91, v64, v65
  ds_read_b128 v[20:23], v1 offset:9216
  ds_read_b128 v[24:27], v1 offset:9232
  ds_read_b128 v[28:31], v1 offset:9248
  ds_read_b128 v[44:47], v1 offset:9264
  ds_read_b128 v[48:51], v1 offset:9280
  ds_read_b128 v[52:55], v1 offset:9296
  s_nop 1
  v_mfma_f32_16x16x32_f16 v[108:111], v[76:79], v[92:95], 0
  v_mfma_f32_16x16x32_f16 v[112:115], v[80:83], v[96:99], 0
  v_mfma_f32_16x16x32_f16 v[116:119], v[84:87], v[100:103], 0
  v_mfma_f32_16x16x32_f16 v[120:123], v[88:91], v[104:107], 0
  s_waitcnt lgkmcnt(0)
  v_pk_mul_f32 v[32:33], v[20:21], v[14:15] op_sel_hi:[1,0]
  v_pk_mul_f32 v[56:57], v[44:45], v[14:15] op_sel_hi:[1,0]
  v_mul_f32 v32, 0xbfb8aa3b, v32
  v_mul_f32 v56, 0xbfb8aa3b, v56
  v_mul_f32 v33, 0xbe22f983, v33
  v_mul_f32 v57, 0xbe22f983, v57
  v_exp_f32 v32, v32
  v_exp_f32 v56, v56
  v_fract_f32 v33, v33
  v_fract_f32 v57, v57
  v_cos_f32 v36, v33
  v_cos_f32 v60, v57
  v_sin_f32 v37, v33
  v_sin_f32 v61, v57
  s_nop 0
  s_nop 0
  v_pk_mul_f32 v[36:37], v[36:37], v[32:33] op_sel_hi:[1,0]
  v_pk_mul_f32 v[60:61], v[60:61], v[56:57] op_sel_hi:[1,0]
  v_cvt_pk_f16_f32 v92, v36, v37
  v_cvt_pk_f16_f32 v93, v60, v61
  v_pk_mul_f32 v[34:35], v[36:37], v[36:37] op_sel:[1,1] op_sel_hi:[1,0]
  v_pk_mul_f32 v[58:59], v[60:61], v[60:61] op_sel:[1,1] op_sel_hi:[1,0]
  v_pk_fma_f32 v[36:37], v[36:37], v[36:37], v[34:35] op_sel:[0,0,0] op_sel_hi:[0,1,1] neg_lo:[0,0,1]
  v_pk_fma_f32 v[60:61], v[60:61], v[60:61], v[58:59] op_sel:[0,0,0] op_sel_hi:[0,1,1] neg_lo:[0,0,1]
  v_cvt_pk_f16_f32 v96, v36, v37
  v_cvt_pk_f16_f32 v97, v60, v61
  v_pk_mul_f32 v[34:35], v[36:37], v[36:37] op_sel:[1,1] op_sel_hi:[1,0]
  v_pk_mul_f32 v[58:59], v[60:61], v[60:61] op_sel:[1,1] op_sel_hi:[1,0]
  v_pk_fma_f32 v[36:37], v[36:37], v[36:37], v[34:35] op_sel:[0,0,0] op_sel_hi:[0,1,1] neg_lo:[0,0,1]
  v_pk_fma_f32 v[60:61], v[60:61], v[60:61], v[58:59] op_sel:[0,0,0] op_sel_hi:[0,1,1] neg_lo:[0,0,1]
  v_cvt_pk_f16_f32 v100, v36, v37
  v_cvt_pk_f16_f32 v101, v60, v61
  v_pk_mul_f32 v[34:35], v[36:37], v[36:37] op_sel:[1,1] op_sel_hi:[1,0]
  v_pk_mul_f32 v[58:59], v[60:61], v[60:61] op_sel:[1,1] op_sel_hi:[1,0]
  v_pk_fma_f32 v[36:37], v[36:37], v[36:37], v[34:35] op_sel:[0,0,0] op_sel_hi:[0,1,1] neg_lo:[0,0,1]
  v_pk_fma_f32 v[60:61], v[60:61], v[60:61], v[58:59] op_sel:[0,0,0] op_sel_hi:[0,1,1] neg_lo:[0,0,1]
  v_cvt_pk_f16_f32 v104, v36, v37
  v_cvt_pk_f16_f32 v105, v60, v61
  v_pk_mul_f32 v[34:35], v[36:37], v[36:37] op_sel:[1,1] op_sel_hi:[1,0]
  v_pk_mul_f32 v[58:59], v[60:61], v[60:61] op_sel:[1,1] op_sel_hi:[1,0]
  v_pk_fma_f32 v[38:39], v[36:37], v[36:37], v[34:35] op_sel:[0,0,0] op_sel_hi:[0,1,1] neg_lo:[0,0,1]
  v_pk_fma_f32 v[62:63], v[60:61], v[60:61], v[58:59] op_sel:[0,0,0] op_sel_hi:[0,1,1] neg_lo:[0,0,1]
  v_xor_b32 v39, 0x80000000, v39
  v_xor_b32 v63, 0x80000000, v63
  v_pk_mul_f32 v[34:35], v[38:39], v[24:25] op_sel:[1,1] op_sel_hi:[1,0]
  v_pk_mul_f32 v[58:59], v[62:63], v[48:49] op_sel:[1,1] op_sel_hi:[1,0]
  v_pk_fma_f32 v[40:41], v[38:39], v[24:25], v[34:35] op_sel:[0,0,0] op_sel_hi:[0,1,1] neg_lo:[0,0,1]
  v_pk_fma_f32 v[64:65], v[62:63], v[48:49], v[58:59] op_sel:[0,0,0] op_sel_hi:[0,1,1] neg_lo:[0,0,1]
  v_pk_mul_f32 v[34:35], v[38:39], v[38:39] op_sel:[1,1] op_sel_hi:[1,0]
  v_pk_mul_f32 v[58:59], v[62:63], v[62:63] op_sel:[1,1] op_sel_hi:[1,0]
  v_pk_fma_f32 v[38:39], v[38:39], v[38:39], v[34:35] op_sel:[0,0,0] op_sel_hi:[0,1,1] neg_lo:[0,0,1]
  v_pk_fma_f32 v[62:63], v[62:63], v[62:63], v[58:59] op_sel:[0,0,0] op_sel_hi:[0,1,1] neg_lo:[0,0,1]
  v_cvt_pk_f16_f32 v76, v40, v41
  v_cvt_pk_f16_f32 v77, v64, v65
  v_pk_mul_f32 v[34:35], v[38:39], v[26:27] op_sel:[1,1] op_sel_hi:[1,0]
  v_pk_mul_f32 v[58:59], v[62:63], v[50:51] op_sel:[1,1] op_sel_hi:[1,0]
  v_pk_fma_f32 v[40:41], v[38:39], v[26:27], v[34:35] op_sel:[0,0,0] op_sel_hi:[0,1,1] neg_lo:[0,0,1]
  v_pk_fma_f32 v[64:65], v[62:63], v[50:51], v[58:59] op_sel:[0,0,0] op_sel_hi:[0,1,1] neg_lo:[0,0,1]
  v_pk_mul_f32 v[34:35], v[38:39], v[38:39] op_sel:[1,1] op_sel_hi:[1,0]
  v_pk_mul_f32 v[58:59], v[62:63], v[62:63] op_sel:[1,1] op_sel_hi:[1,0]
  v_pk_fma_f32 v[38:39], v[38:39], v[38:39], v[34:35] op_sel:[0,0,0] op_sel_hi:[0,1,1] neg_lo:[0,0,1]
  v_pk_fma_f32 v[62:63], v[62:63], v[62:63], v[58:59] op_sel:[0,0,0] op_sel_hi:[0,1,1] neg_lo:[0,0,1]
  v_cvt_pk_f16_f32 v80, v40, v41
  v_cvt_pk_f16_f32 v81, v64, v65
  v_pk_mul_f32 v[34:35], v[38:39], v[28:29] op_sel:[1,1] op_sel_hi:[1,0]
  v_pk_mul_f32 v[58:59], v[62:63], v[52:53] op_sel:[1,1] op_sel_hi:[1,0]
  v_pk_fma_f32 v[40:41], v[38:39], v[28:29], v[34:35] op_sel:[0,0,0] op_sel_hi:[0,1,1] neg_lo:[0,0,1]
  v_pk_fma_f32 v[64:65], v[62:63], v[52:53], v[58:59] op_sel:[0,0,0] op_sel_hi:[0,1,1] neg_lo:[0,0,1]
  v_pk_mul_f32 v[34:35], v[38:39], v[38:39] op_sel:[1,1] op_sel_hi:[1,0]
  v_pk_mul_f32 v[58:59], v[62:63], v[62:63] op_sel:[1,1] op_sel_hi:[1,0]
  v_pk_fma_f32 v[38:39], v[38:39], v[38:39], v[34:35] op_sel:[0,0,0] op_sel_hi:[0,1,1] neg_lo:[0,0,1]
  v_pk_fma_f32 v[62:63], v[62:63], v[62:63], v[58:59] op_sel:[0,0,0] op_sel_hi:[0,1,1] neg_lo:[0,0,1]
  v_cvt_pk_f16_f32 v84, v40, v41
  v_cvt_pk_f16_f32 v85, v64, v65
  v_pk_mul_f32 v[34:35], v[38:39], v[30:31] op_sel:[1,1] op_sel_hi:[1,0]
  v_pk_mul_f32 v[58:59], v[62:63], v[54:55] op_sel:[1,1] op_sel_hi:[1,0]
  v_pk_fma_f32 v[40:41], v[38:39], v[30:31], v[34:35] op_sel:[0,0,0] op_sel_hi:[0,1,1] neg_lo:[0,0,1]
  v_pk_fma_f32 v[64:65], v[62:63], v[54:55], v[58:59] op_sel:[0,0,0] op_sel_hi:[0,1,1] neg_lo:[0,0,1]
  v_cvt_pk_f16_f32 v88, v40, v41
  v_cvt_pk_f16_f32 v89, v64, v65
  ds_read_b128 v[20:23], v1 offset:9312
  ds_read_b128 v[24:27], v1 offset:9328
  ds_read_b128 v[28:31], v1 offset:9344
  ds_read_b128 v[44:47], v1 offset:9360
  ds_read_b128 v[48:51], v1 offset:9376
  ds_read_b128 v[52:55], v1 offset:9392
  s_waitcnt lgkmcnt(0)
  v_pk_mul_f32 v[32:33], v[20:21], v[14:15] op_sel_hi:[1,0]
  v_pk_mul_f32 v[56:57], v[44:45], v[14:15] op_sel_hi:[1,0]
  v_mul_f32 v32, 0xbfb8aa3b, v32
  v_mul_f32 v56, 0xbfb8aa3b, v56
  v_mul_f32 v33, 0xbe22f983, v33
  v_mul_f32 v57, 0xbe22f983, v57
  v_exp_f32 v32, v32
  v_exp_f32 v56, v56
  v_fract_f32 v33, v33
  v_fract_f32 v57, v57
  v_cos_f32 v36, v33
  v_cos_f32 v60, v57
  v_sin_f32 v37, v33
  v_sin_f32 v61, v57
  s_nop 0
  s_nop 0
  v_pk_mul_f32 v[36:37], v[36:37], v[32:33] op_sel_hi:[1,0]
  v_pk_mul_f32 v[60:61], v[60:61], v[56:57] op_sel_hi:[1,0]
  v_cvt_pk_f16_f32 v94, v36, v37
  v_cvt_pk_f16_f32 v95, v60, v61
  v_pk_mul_f32 v[34:35], v[36:37], v[36:37] op_sel:[1,1] op_sel_hi:[1,0]
  v_pk_mul_f32 v[58:59], v[60:61], v[60:61] op_sel:[1,1] op_sel_hi:[1,0]
  v_pk_fma_f32 v[36:37], v[36:37], v[36:37], v[34:35] op_sel:[0,0,0] op_sel_hi:[0,1,1] neg_lo:[0,0,1]
  v_pk_fma_f32 v[60:61], v[60:61], v[60:61], v[58:59] op_sel:[0,0,0] op_sel_hi:[0,1,1] neg_lo:[0,0,1]
  v_cvt_pk_f16_f32 v98, v36, v37
  v_cvt_pk_f16_f32 v99, v60, v61
  v_pk_mul_f32 v[34:35], v[36:37], v[36:37] op_sel:[1,1] op_sel_hi:[1,0]
  v_pk_mul_f32 v[58:59], v[60:61], v[60:61] op_sel:[1,1] op_sel_hi:[1,0]
  v_pk_fma_f32 v[36:37], v[36:37], v[36:37], v[34:35] op_sel:[0,0,0] op_sel_hi:[0,1,1] neg_lo:[0,0,1]
  v_pk_fma_f32 v[60:61], v[60:61], v[60:61], v[58:59] op_sel:[0,0,0] op_sel_hi:[0,1,1] neg_lo:[0,0,1]
  v_cvt_pk_f16_f32 v102, v36, v37
  v_cvt_pk_f16_f32 v103, v60, v61
  v_pk_mul_f32 v[34:35], v[36:37], v[36:37] op_sel:[1,1] op_sel_hi:[1,0]
  v_pk_mul_f32 v[58:59], v[60:61], v[60:61] op_sel:[1,1] op_sel_hi:[1,0]
  v_pk_fma_f32 v[36:37], v[36:37], v[36:37], v[34:35] op_sel:[0,0,0] op_sel_hi:[0,1,1] neg_lo:[0,0,1]
  v_pk_fma_f32 v[60:61], v[60:61], v[60:61], v[58:59] op_sel:[0,0,0] op_sel_hi:[0,1,1] neg_lo:[0,0,1]
  v_cvt_pk_f16_f32 v106, v36, v37
  v_cvt_pk_f16_f32 v107, v60, v61
  v_pk_mul_f32 v[34:35], v[36:37], v[36:37] op_sel:[1,1] op_sel_hi:[1,0]
  v_pk_mul_f32 v[58:59], v[60:61], v[60:61] op_sel:[1,1] op_sel_hi:[1,0]
  v_pk_fma_f32 v[38:39], v[36:37], v[36:37], v[34:35] op_sel:[0,0,0] op_sel_hi:[0,1,1] neg_lo:[0,0,1]
  v_pk_fma_f32 v[62:63], v[60:61], v[60:61], v[58:59] op_sel:[0,0,0] op_sel_hi:[0,1,1] neg_lo:[0,0,1]
  v_xor_b32 v39, 0x80000000, v39
  v_xor_b32 v63, 0x80000000, v63
  v_pk_mul_f32 v[34:35], v[38:39], v[24:25] op_sel:[1,1] op_sel_hi:[1,0]
  v_pk_mul_f32 v[58:59], v[62:63], v[48:49] op_sel:[1,1] op_sel_hi:[1,0]
  v_pk_fma_f32 v[40:41], v[38:39], v[24:25], v[34:35] op_sel:[0,0,0] op_sel_hi:[0,1,1] neg_lo:[0,0,1]
  v_pk_fma_f32 v[64:65], v[62:63], v[48:49], v[58:59] op_sel:[0,0,0] op_sel_hi:[0,1,1] neg_lo:[0,0,1]
  v_pk_mul_f32 v[34:35], v[38:39], v[38:39] op_sel:[1,1] op_sel_hi:[1,0]
  v_pk_mul_f32 v[58:59], v[62:63], v[62:63] op_sel:[1,1] op_sel_hi:[1,0]
  v_pk_fma_f32 v[38:39], v[38:39], v[38:39], v[34:35] op_sel:[0,0,0] op_sel_hi:[0,1,1] neg_lo:[0,0,1]
  v_pk_fma_f32 v[62:63], v[62:63], v[62:63], v[58:59] op_sel:[0,0,0] op_sel_hi:[0,1,1] neg_lo:[0,0,1]
  v_cvt_pk_f16_f32 v78, v40, v41
  v_cvt_pk_f16_f32 v79, v64, v65
  v_pk_mul_f32 v[34:35], v[38:39], v[26:27] op_sel:[1,1] op_sel_hi:[1,0]
  v_pk_mul_f32 v[58:59], v[62:63], v[50:51] op_sel:[1,1] op_sel_hi:[1,0]
  v_pk_fma_f32 v[40:41], v[38:39], v[26:27], v[34:35] op_sel:[0,0,0] op_sel_hi:[0,1,1] neg_lo:[0,0,1]
  v_pk_fma_f32 v[64:65], v[62:63], v[50:51], v[58:59] op_sel:[0,0,0] op_sel_hi:[0,1,1] neg_lo:[0,0,1]
  v_pk_mul_f32 v[34:35], v[38:39], v[38:39] op_sel:[1,1] op_sel_hi:[1,0]
  v_pk_mul_f32 v[58:59], v[62:63], v[62:63] op_sel:[1,1] op_sel_hi:[1,0]
  v_pk_fma_f32 v[38:39], v[38:39], v[38:39], v[34:35] op_sel:[0,0,0] op_sel_hi:[0,1,1] neg_lo:[0,0,1]
  v_pk_fma_f32 v[62:63], v[62:63], v[62:63], v[58:59] op_sel:[0,0,0] op_sel_hi:[0,1,1] neg_lo:[0,0,1]
  v_cvt_pk_f16_f32 v82, v40, v41
  v_cvt_pk_f16_f32 v83, v64, v65
  v_pk_mul_f32 v[34:35], v[38:39], v[28:29] op_sel:[1,1] op_sel_hi:[1,0]
  v_pk_mul_f32 v[58:59], v[62:63], v[52:53] op_sel:[1,1] op_sel_hi:[1,0]
  v_pk_fma_f32 v[40:41], v[38:39], v[28:29], v[34:35] op_sel:[0,0,0] op_sel_hi:[0,1,1] neg_lo:[0,0,1]
  v_pk_fma_f32 v[64:65], v[62:63], v[52:53], v[58:59] op_sel:[0,0,0] op_sel_hi:[0,1,1] neg_lo:[0,0,1]
  v_pk_mul_f32 v[34:35], v[38:39], v[38:39] op_sel:[1,1] op_sel_hi:[1,0]
  v_pk_mul_f32 v[58:59], v[62:63], v[62:63] op_sel:[1,1] op_sel_hi:[1,0]
  v_pk_fma_f32 v[38:39], v[38:39], v[38:39], v[34:35] op_sel:[0,0,0] op_sel_hi:[0,1,1] neg_lo:[0,0,1]
  v_pk_fma_f32 v[62:63], v[62:63], v[62:63], v[58:59] op_sel:[0,0,0] op_sel_hi:[0,1,1] neg_lo:[0,0,1]
  v_cvt_pk_f16_f32 v86, v40, v41
  v_cvt_pk_f16_f32 v87, v64, v65
  v_pk_mul_f32 v[34:35], v[38:39], v[30:31] op_sel:[1,1] op_sel_hi:[1,0]
  v_pk_mul_f32 v[58:59], v[62:63], v[54:55] op_sel:[1,1] op_sel_hi:[1,0]
  v_pk_fma_f32 v[40:41], v[38:39], v[30:31], v[34:35] op_sel:[0,0,0] op_sel_hi:[0,1,1] neg_lo:[0,0,1]
  v_pk_fma_f32 v[64:65], v[62:63], v[54:55], v[58:59] op_sel:[0,0,0] op_sel_hi:[0,1,1] neg_lo:[0,0,1]
  v_cvt_pk_f16_f32 v90, v40, v41
  v_cvt_pk_f16_f32 v91, v64, v65
  ds_read_b128 v[20:23], v1 offset:9984
  ds_read_b128 v[24:27], v1 offset:10000
  ds_read_b128 v[28:31], v1 offset:10016
  ds_read_b128 v[44:47], v1 offset:10032
  ds_read_b128 v[48:51], v1 offset:10048
  ds_read_b128 v[52:55], v1 offset:10064
  s_nop 1
  v_mfma_f32_16x16x32_f16 v[108:111], v[76:79], v[92:95], v[108:111]
  v_mfma_f32_16x16x32_f16 v[112:115], v[80:83], v[96:99], v[112:115]
  v_mfma_f32_16x16x32_f16 v[116:119], v[84:87], v[100:103], v[116:119]
  v_mfma_f32_16x16x32_f16 v[120:123], v[88:91], v[104:107], v[120:123]
  s_waitcnt lgkmcnt(0)
  v_pk_mul_f32 v[32:33], v[20:21], v[14:15] op_sel_hi:[1,0]
  v_pk_mul_f32 v[56:57], v[44:45], v[14:15] op_sel_hi:[1,0]
  v_mul_f32 v32, 0xbfb8aa3b, v32
  v_mul_f32 v56, 0xbfb8aa3b, v56
  v_mul_f32 v33, 0xbe22f983, v33
  v_mul_f32 v57, 0xbe22f983, v57
  v_exp_f32 v32, v32
  v_exp_f32 v56, v56
  v_fract_f32 v33, v33
  v_fract_f32 v57, v57
  v_cos_f32 v36, v33
  v_cos_f32 v60, v57
  v_sin_f32 v37, v33
  v_sin_f32 v61, v57
  s_nop 0
  s_nop 0
  v_pk_mul_f32 v[36:37], v[36:37], v[32:33] op_sel_hi:[1,0]
  v_pk_mul_f32 v[60:61], v[60:61], v[56:57] op_sel_hi:[1,0]
  v_cvt_pk_f16_f32 v92, v36, v37
  v_cvt_pk_f16_f32 v93, v60, v61
  v_pk_mul_f32 v[34:35], v[36:37], v[36:37] op_sel:[1,1] op_sel_hi:[1,0]
  v_pk_mul_f32 v[58:59], v[60:61], v[60:61] op_sel:[1,1] op_sel_hi:[1,0]
  v_pk_fma_f32 v[36:37], v[36:37], v[36:37], v[34:35] op_sel:[0,0,0] op_sel_hi:[0,1,1] neg_lo:[0,0,1]
  v_pk_fma_f32 v[60:61], v[60:61], v[60:61], v[58:59] op_sel:[0,0,0] op_sel_hi:[0,1,1] neg_lo:[0,0,1]
  v_cvt_pk_f16_f32 v96, v36, v37
  v_cvt_pk_f16_f32 v97, v60, v61
  v_pk_mul_f32 v[34:35], v[36:37], v[36:37] op_sel:[1,1] op_sel_hi:[1,0]
  v_pk_mul_f32 v[58:59], v[60:61], v[60:61] op_sel:[1,1] op_sel_hi:[1,0]
  v_pk_fma_f32 v[36:37], v[36:37], v[36:37], v[34:35] op_sel:[0,0,0] op_sel_hi:[0,1,1] neg_lo:[0,0,1]
  v_pk_fma_f32 v[60:61], v[60:61], v[60:61], v[58:59] op_sel:[0,0,0] op_sel_hi:[0,1,1] neg_lo:[0,0,1]
  v_cvt_pk_f16_f32 v100, v36, v37
  v_cvt_pk_f16_f32 v101, v60, v61
  v_pk_mul_f32 v[34:35], v[36:37], v[36:37] op_sel:[1,1] op_sel_hi:[1,0]
  v_pk_mul_f32 v[58:59], v[60:61], v[60:61] op_sel:[1,1] op_sel_hi:[1,0]
  v_pk_fma_f32 v[36:37], v[36:37], v[36:37], v[34:35] op_sel:[0,0,0] op_sel_hi:[0,1,1] neg_lo:[0,0,1]
  v_pk_fma_f32 v[60:61], v[60:61], v[60:61], v[58:59] op_sel:[0,0,0] op_sel_hi:[0,1,1] neg_lo:[0,0,1]
  v_cvt_pk_f16_f32 v104, v36, v37
  v_cvt_pk_f16_f32 v105, v60, v61
  v_pk_mul_f32 v[34:35], v[36:37], v[36:37] op_sel:[1,1] op_sel_hi:[1,0]
  v_pk_mul_f32 v[58:59], v[60:61], v[60:61] op_sel:[1,1] op_sel_hi:[1,0]
  v_pk_fma_f32 v[38:39], v[36:37], v[36:37], v[34:35] op_sel:[0,0,0] op_sel_hi:[0,1,1] neg_lo:[0,0,1]
  v_pk_fma_f32 v[62:63], v[60:61], v[60:61], v[58:59] op_sel:[0,0,0] op_sel_hi:[0,1,1] neg_lo:[0,0,1]
  v_xor_b32 v39, 0x80000000, v39
  v_xor_b32 v63, 0x80000000, v63
  v_pk_mul_f32 v[34:35], v[38:39], v[24:25] op_sel:[1,1] op_sel_hi:[1,0]
  v_pk_mul_f32 v[58:59], v[62:63], v[48:49] op_sel:[1,1] op_sel_hi:[1,0]
  v_pk_fma_f32 v[40:41], v[38:39], v[24:25], v[34:35] op_sel:[0,0,0] op_sel_hi:[0,1,1] neg_lo:[0,0,1]
  v_pk_fma_f32 v[64:65], v[62:63], v[48:49], v[58:59] op_sel:[0,0,0] op_sel_hi:[0,1,1] neg_lo:[0,0,1]
  v_pk_mul_f32 v[34:35], v[38:39], v[38:39] op_sel:[1,1] op_sel_hi:[1,0]
  v_pk_mul_f32 v[58:59], v[62:63], v[62:63] op_sel:[1,1] op_sel_hi:[1,0]
  v_pk_fma_f32 v[38:39], v[38:39], v[38:39], v[34:35] op_sel:[0,0,0] op_sel_hi:[0,1,1] neg_lo:[0,0,1]
  v_pk_fma_f32 v[62:63], v[62:63], v[62:63], v[58:59] op_sel:[0,0,0] op_sel_hi:[0,1,1] neg_lo:[0,0,1]
  v_cvt_pk_f16_f32 v76, v40, v41
  v_cvt_pk_f16_f32 v77, v64, v65
  v_pk_mul_f32 v[34:35], v[38:39], v[26:27] op_sel:[1,1] op_sel_hi:[1,0]
  v_pk_mul_f32 v[58:59], v[62:63], v[50:51] op_sel:[1,1] op_sel_hi:[1,0]
  v_pk_fma_f32 v[40:41], v[38:39], v[26:27], v[34:35] op_sel:[0,0,0] op_sel_hi:[0,1,1] neg_lo:[0,0,1]
  v_pk_fma_f32 v[64:65], v[62:63], v[50:51], v[58:59] op_sel:[0,0,0] op_sel_hi:[0,1,1] neg_lo:[0,0,1]
  v_pk_mul_f32 v[34:35], v[38:39], v[38:39] op_sel:[1,1] op_sel_hi:[1,0]
  v_pk_mul_f32 v[58:59], v[62:63], v[62:63] op_sel:[1,1] op_sel_hi:[1,0]
  v_pk_fma_f32 v[38:39], v[38:39], v[38:39], v[34:35] op_sel:[0,0,0] op_sel_hi:[0,1,1] neg_lo:[0,0,1]
  v_pk_fma_f32 v[62:63], v[62:63], v[62:63], v[58:59] op_sel:[0,0,0] op_sel_hi:[0,1,1] neg_lo:[0,0,1]
  v_cvt_pk_f16_f32 v80, v40, v41
  v_cvt_pk_f16_f32 v81, v64, v65
  v_pk_mul_f32 v[34:35], v[38:39], v[28:29] op_sel:[1,1] op_sel_hi:[1,0]
  v_pk_mul_f32 v[58:59], v[62:63], v[52:53] op_sel:[1,1] op_sel_hi:[1,0]
  v_pk_fma_f32 v[40:41], v[38:39], v[28:29], v[34:35] op_sel:[0,0,0] op_sel_hi:[0,1,1] neg_lo:[0,0,1]
  v_pk_fma_f32 v[64:65], v[62:63], v[52:53], v[58:59] op_sel:[0,0,0] op_sel_hi:[0,1,1] neg_lo:[0,0,1]
  v_pk_mul_f32 v[34:35], v[38:39], v[38:39] op_sel:[1,1] op_sel_hi:[1,0]
  v_pk_mul_f32 v[58:59], v[62:63], v[62:63] op_sel:[1,1] op_sel_hi:[1,0]
  v_pk_fma_f32 v[38:39], v[38:39], v[38:39], v[34:35] op_sel:[0,0,0] op_sel_hi:[0,1,1] neg_lo:[0,0,1]
  v_pk_fma_f32 v[62:63], v[62:63], v[62:63], v[58:59] op_sel:[0,0,0] op_sel_hi:[0,1,1] neg_lo:[0,0,1]
  v_cvt_pk_f16_f32 v84, v40, v41
  v_cvt_pk_f16_f32 v85, v64, v65
  v_pk_mul_f32 v[34:35], v[38:39], v[30:31] op_sel:[1,1] op_sel_hi:[1,0]
  v_pk_mul_f32 v[58:59], v[62:63], v[54:55] op_sel:[1,1] op_sel_hi:[1,0]
  v_pk_fma_f32 v[40:41], v[38:39], v[30:31], v[34:35] op_sel:[0,0,0] op_sel_hi:[0,1,1] neg_lo:[0,0,1]
  v_pk_fma_f32 v[64:65], v[62:63], v[54:55], v[58:59] op_sel:[0,0,0] op_sel_hi:[0,1,1] neg_lo:[0,0,1]
  v_cvt_pk_f16_f32 v88, v40, v41
  v_cvt_pk_f16_f32 v89, v64, v65
  ds_read_b128 v[20:23], v1 offset:10080
  ds_read_b128 v[24:27], v1 offset:10096
  ds_read_b128 v[28:31], v1 offset:10112
  ds_read_b128 v[44:47], v1 offset:10128
  ds_read_b128 v[48:51], v1 offset:10144
  ds_read_b128 v[52:55], v1 offset:10160
  s_waitcnt lgkmcnt(0)
  v_pk_mul_f32 v[32:33], v[20:21], v[14:15] op_sel_hi:[1,0]
  v_pk_mul_f32 v[56:57], v[44:45], v[14:15] op_sel_hi:[1,0]
  v_mul_f32 v32, 0xbfb8aa3b, v32
  v_mul_f32 v56, 0xbfb8aa3b, v56
  v_mul_f32 v33, 0xbe22f983, v33
  v_mul_f32 v57, 0xbe22f983, v57
  v_exp_f32 v32, v32
  v_exp_f32 v56, v56
  v_fract_f32 v33, v33
  v_fract_f32 v57, v57
  v_cos_f32 v36, v33
  v_cos_f32 v60, v57
  v_sin_f32 v37, v33
  v_sin_f32 v61, v57
  s_nop 0
  s_nop 0
  v_pk_mul_f32 v[36:37], v[36:37], v[32:33] op_sel_hi:[1,0]
  v_pk_mul_f32 v[60:61], v[60:61], v[56:57] op_sel_hi:[1,0]
  v_cvt_pk_f16_f32 v94, v36, v37
  v_cvt_pk_f16_f32 v95, v60, v61
  v_pk_mul_f32 v[34:35], v[36:37], v[36:37] op_sel:[1,1] op_sel_hi:[1,0]
  v_pk_mul_f32 v[58:59], v[60:61], v[60:61] op_sel:[1,1] op_sel_hi:[1,0]
  v_pk_fma_f32 v[36:37], v[36:37], v[36:37], v[34:35] op_sel:[0,0,0] op_sel_hi:[0,1,1] neg_lo:[0,0,1]
  v_pk_fma_f32 v[60:61], v[60:61], v[60:61], v[58:59] op_sel:[0,0,0] op_sel_hi:[0,1,1] neg_lo:[0,0,1]
  v_cvt_pk_f16_f32 v98, v36, v37
  v_cvt_pk_f16_f32 v99, v60, v61
  v_pk_mul_f32 v[34:35], v[36:37], v[36:37] op_sel:[1,1] op_sel_hi:[1,0]
  v_pk_mul_f32 v[58:59], v[60:61], v[60:61] op_sel:[1,1] op_sel_hi:[1,0]
  v_pk_fma_f32 v[36:37], v[36:37], v[36:37], v[34:35] op_sel:[0,0,0] op_sel_hi:[0,1,1] neg_lo:[0,0,1]
  v_pk_fma_f32 v[60:61], v[60:61], v[60:61], v[58:59] op_sel:[0,0,0] op_sel_hi:[0,1,1] neg_lo:[0,0,1]
  v_cvt_pk_f16_f32 v102, v36, v37
  v_cvt_pk_f16_f32 v103, v60, v61
  v_pk_mul_f32 v[34:35], v[36:37], v[36:37] op_sel:[1,1] op_sel_hi:[1,0]
  v_pk_mul_f32 v[58:59], v[60:61], v[60:61] op_sel:[1,1] op_sel_hi:[1,0]
  v_pk_fma_f32 v[36:37], v[36:37], v[36:37], v[34:35] op_sel:[0,0,0] op_sel_hi:[0,1,1] neg_lo:[0,0,1]
  v_pk_fma_f32 v[60:61], v[60:61], v[60:61], v[58:59] op_sel:[0,0,0] op_sel_hi:[0,1,1] neg_lo:[0,0,1]
  v_cvt_pk_f16_f32 v106, v36, v37
  v_cvt_pk_f16_f32 v107, v60, v61
  v_pk_mul_f32 v[34:35], v[36:37], v[36:37] op_sel:[1,1] op_sel_hi:[1,0]
  v_pk_mul_f32 v[58:59], v[60:61], v[60:61] op_sel:[1,1] op_sel_hi:[1,0]
  v_pk_fma_f32 v[38:39], v[36:37], v[36:37], v[34:35] op_sel:[0,0,0] op_sel_hi:[0,1,1] neg_lo:[0,0,1]
  v_pk_fma_f32 v[62:63], v[60:61], v[60:61], v[58:59] op_sel:[0,0,0] op_sel_hi:[0,1,1] neg_lo:[0,0,1]
  v_xor_b32 v39, 0x80000000, v39
  v_xor_b32 v63, 0x80000000, v63
  v_pk_mul_f32 v[34:35], v[38:39], v[24:25] op_sel:[1,1] op_sel_hi:[1,0]
  v_pk_mul_f32 v[58:59], v[62:63], v[48:49] op_sel:[1,1] op_sel_hi:[1,0]
  v_pk_fma_f32 v[40:41], v[38:39], v[24:25], v[34:35] op_sel:[0,0,0] op_sel_hi:[0,1,1] neg_lo:[0,0,1]
  v_pk_fma_f32 v[64:65], v[62:63], v[48:49], v[58:59] op_sel:[0,0,0] op_sel_hi:[0,1,1] neg_lo:[0,0,1]
  v_pk_mul_f32 v[34:35], v[38:39], v[38:39] op_sel:[1,1] op_sel_hi:[1,0]
  v_pk_mul_f32 v[58:59], v[62:63], v[62:63] op_sel:[1,1] op_sel_hi:[1,0]
  v_pk_fma_f32 v[38:39], v[38:39], v[38:39], v[34:35] op_sel:[0,0,0] op_sel_hi:[0,1,1] neg_lo:[0,0,1]
  v_pk_fma_f32 v[62:63], v[62:63], v[62:63], v[58:59] op_sel:[0,0,0] op_sel_hi:[0,1,1] neg_lo:[0,0,1]
  v_cvt_pk_f16_f32 v78, v40, v41
  v_cvt_pk_f16_f32 v79, v64, v65
  v_pk_mul_f32 v[34:35], v[38:39], v[26:27] op_sel:[1,1] op_sel_hi:[1,0]
  v_pk_mul_f32 v[58:59], v[62:63], v[50:51] op_sel:[1,1] op_sel_hi:[1,0]
  v_pk_fma_f32 v[40:41], v[38:39], v[26:27], v[34:35] op_sel:[0,0,0] op_sel_hi:[0,1,1] neg_lo:[0,0,1]
  v_pk_fma_f32 v[64:65], v[62:63], v[50:51], v[58:59] op_sel:[0,0,0] op_sel_hi:[0,1,1] neg_lo:[0,0,1]
  v_pk_mul_f32 v[34:35], v[38:39], v[38:39] op_sel:[1,1] op_sel_hi:[1,0]
  v_pk_mul_f32 v[58:59], v[62:63], v[62:63] op_sel:[1,1] op_sel_hi:[1,0]
  v_pk_fma_f32 v[38:39], v[38:39], v[38:39], v[34:35] op_sel:[0,0,0] op_sel_hi:[0,1,1] neg_lo:[0,0,1]
  v_pk_fma_f32 v[62:63], v[62:63], v[62:63], v[58:59] op_sel:[0,0,0] op_sel_hi:[0,1,1] neg_lo:[0,0,1]
  v_cvt_pk_f16_f32 v82, v40, v41
  v_cvt_pk_f16_f32 v83, v64, v65
  v_pk_mul_f32 v[34:35], v[38:39], v[28:29] op_sel:[1,1] op_sel_hi:[1,0]
  v_pk_mul_f32 v[58:59], v[62:63], v[52:53] op_sel:[1,1] op_sel_hi:[1,0]
  v_pk_fma_f32 v[40:41], v[38:39], v[28:29], v[34:35] op_sel:[0,0,0] op_sel_hi:[0,1,1] neg_lo:[0,0,1]
  v_pk_fma_f32 v[64:65], v[62:63], v[52:53], v[58:59] op_sel:[0,0,0] op_sel_hi:[0,1,1] neg_lo:[0,0,1]
  v_pk_mul_f32 v[34:35], v[38:39], v[38:39] op_sel:[1,1] op_sel_hi:[1,0]
  v_pk_mul_f32 v[58:59], v[62:63], v[62:63] op_sel:[1,1] op_sel_hi:[1,0]
  v_pk_fma_f32 v[38:39], v[38:39], v[38:39], v[34:35] op_sel:[0,0,0] op_sel_hi:[0,1,1] neg_lo:[0,0,1]
  v_pk_fma_f32 v[62:63], v[62:63], v[62:63], v[58:59] op_sel:[0,0,0] op_sel_hi:[0,1,1] neg_lo:[0,0,1]
  v_cvt_pk_f16_f32 v86, v40, v41
  v_cvt_pk_f16_f32 v87, v64, v65
  v_pk_mul_f32 v[34:35], v[38:39], v[30:31] op_sel:[1,1] op_sel_hi:[1,0]
  v_pk_mul_f32 v[58:59], v[62:63], v[54:55] op_sel:[1,1] op_sel_hi:[1,0]
  v_pk_fma_f32 v[40:41], v[38:39], v[30:31], v[34:35] op_sel:[0,0,0] op_sel_hi:[0,1,1] neg_lo:[0,0,1]
  v_pk_fma_f32 v[64:65], v[62:63], v[54:55], v[58:59] op_sel:[0,0,0] op_sel_hi:[0,1,1] neg_lo:[0,0,1]
  v_cvt_pk_f16_f32 v90, v40, v41
  v_cvt_pk_f16_f32 v91, v64, v65
  ds_read_b128 v[20:23], v1 offset:10752
  ds_read_b128 v[24:27], v1 offset:10768
  ds_read_b128 v[28:31], v1 offset:10784
  ds_read_b128 v[44:47], v1 offset:10800
  ds_read_b128 v[48:51], v1 offset:10816
  ds_read_b128 v[52:55], v1 offset:10832
  s_nop 1
  v_mfma_f32_16x16x32_f16 v[108:111], v[76:79], v[92:95], v[108:111]
  v_mfma_f32_16x16x32_f16 v[112:115], v[80:83], v[96:99], v[112:115]
  v_mfma_f32_16x16x32_f16 v[116:119], v[84:87], v[100:103], v[116:119]
  v_mfma_f32_16x16x32_f16 v[120:123], v[88:91], v[104:107], v[120:123]
  s_waitcnt lgkmcnt(0)
  v_pk_mul_f32 v[32:33], v[20:21], v[14:15] op_sel_hi:[1,0]
  v_pk_mul_f32 v[56:57], v[44:45], v[14:15] op_sel_hi:[1,0]
  v_mul_f32 v32, 0xbfb8aa3b, v32
  v_mul_f32 v56, 0xbfb8aa3b, v56
  v_mul_f32 v33, 0xbe22f983, v33
  v_mul_f32 v57, 0xbe22f983, v57
  v_exp_f32 v32, v32
  v_exp_f32 v56, v56
  v_fract_f32 v33, v33
  v_fract_f32 v57, v57
  v_cos_f32 v36, v33
  v_cos_f32 v60, v57
  v_sin_f32 v37, v33
  v_sin_f32 v61, v57
  s_nop 0
  s_nop 0
  v_pk_mul_f32 v[36:37], v[36:37], v[32:33] op_sel_hi:[1,0]
  v_pk_mul_f32 v[60:61], v[60:61], v[56:57] op_sel_hi:[1,0]
  v_cvt_pk_f16_f32 v92, v36, v37
  v_cvt_pk_f16_f32 v93, v60, v61
  v_pk_mul_f32 v[34:35], v[36:37], v[36:37] op_sel:[1,1] op_sel_hi:[1,0]
  v_pk_mul_f32 v[58:59], v[60:61], v[60:61] op_sel:[1,1] op_sel_hi:[1,0]
  v_pk_fma_f32 v[36:37], v[36:37], v[36:37], v[34:35] op_sel:[0,0,0] op_sel_hi:[0,1,1] neg_lo:[0,0,1]
  v_pk_fma_f32 v[60:61], v[60:61], v[60:61], v[58:59] op_sel:[0,0,0] op_sel_hi:[0,1,1] neg_lo:[0,0,1]
  v_cvt_pk_f16_f32 v96, v36, v37
  v_cvt_pk_f16_f32 v97, v60, v61
  v_pk_mul_f32 v[34:35], v[36:37], v[36:37] op_sel:[1,1] op_sel_hi:[1,0]
  v_pk_mul_f32 v[58:59], v[60:61], v[60:61] op_sel:[1,1] op_sel_hi:[1,0]
  v_pk_fma_f32 v[36:37], v[36:37], v[36:37], v[34:35] op_sel:[0,0,0] op_sel_hi:[0,1,1] neg_lo:[0,0,1]
  v_pk_fma_f32 v[60:61], v[60:61], v[60:61], v[58:59] op_sel:[0,0,0] op_sel_hi:[0,1,1] neg_lo:[0,0,1]
  v_cvt_pk_f16_f32 v100, v36, v37
  v_cvt_pk_f16_f32 v101, v60, v61
  v_pk_mul_f32 v[34:35], v[36:37], v[36:37] op_sel:[1,1] op_sel_hi:[1,0]
  v_pk_mul_f32 v[58:59], v[60:61], v[60:61] op_sel:[1,1] op_sel_hi:[1,0]
  v_pk_fma_f32 v[36:37], v[36:37], v[36:37], v[34:35] op_sel:[0,0,0] op_sel_hi:[0,1,1] neg_lo:[0,0,1]
  v_pk_fma_f32 v[60:61], v[60:61], v[60:61], v[58:59] op_sel:[0,0,0] op_sel_hi:[0,1,1] neg_lo:[0,0,1]
  v_cvt_pk_f16_f32 v104, v36, v37
  v_cvt_pk_f16_f32 v105, v60, v61
  v_pk_mul_f32 v[34:35], v[36:37], v[36:37] op_sel:[1,1] op_sel_hi:[1,0]
  v_pk_mul_f32 v[58:59], v[60:61], v[60:61] op_sel:[1,1] op_sel_hi:[1,0]
  v_pk_fma_f32 v[38:39], v[36:37], v[36:37], v[34:35] op_sel:[0,0,0] op_sel_hi:[0,1,1] neg_lo:[0,0,1]
  v_pk_fma_f32 v[62:63], v[60:61], v[60:61], v[58:59] op_sel:[0,0,0] op_sel_hi:[0,1,1] neg_lo:[0,0,1]
  v_xor_b32 v39, 0x80000000, v39
  v_xor_b32 v63, 0x80000000, v63
  v_pk_mul_f32 v[34:35], v[38:39], v[24:25] op_sel:[1,1] op_sel_hi:[1,0]
  v_pk_mul_f32 v[58:59], v[62:63], v[48:49] op_sel:[1,1] op_sel_hi:[1,0]
  v_pk_fma_f32 v[40:41], v[38:39], v[24:25], v[34:35] op_sel:[0,0,0] op_sel_hi:[0,1,1] neg_lo:[0,0,1]
  v_pk_fma_f32 v[64:65], v[62:63], v[48:49], v[58:59] op_sel:[0,0,0] op_sel_hi:[0,1,1] neg_lo:[0,0,1]
  v_pk_mul_f32 v[34:35], v[38:39], v[38:39] op_sel:[1,1] op_sel_hi:[1,0]
  v_pk_mul_f32 v[58:59], v[62:63], v[62:63] op_sel:[1,1] op_sel_hi:[1,0]
  v_pk_fma_f32 v[38:39], v[38:39], v[38:39], v[34:35] op_sel:[0,0,0] op_sel_hi:[0,1,1] neg_lo:[0,0,1]
  v_pk_fma_f32 v[62:63], v[62:63], v[62:63], v[58:59] op_sel:[0,0,0] op_sel_hi:[0,1,1] neg_lo:[0,0,1]
  v_cvt_pk_f16_f32 v76, v40, v41
  v_cvt_pk_f16_f32 v77, v64, v65
  v_pk_mul_f32 v[34:35], v[38:39], v[26:27] op_sel:[1,1] op_sel_hi:[1,0]
  v_pk_mul_f32 v[58:59], v[62:63], v[50:51] op_sel:[1,1] op_sel_hi:[1,0]
  v_pk_fma_f32 v[40:41], v[38:39], v[26:27], v[34:35] op_sel:[0,0,0] op_sel_hi:[0,1,1] neg_lo:[0,0,1]
  v_pk_fma_f32 v[64:65], v[62:63], v[50:51], v[58:59] op_sel:[0,0,0] op_sel_hi:[0,1,1] neg_lo:[0,0,1]
  v_pk_mul_f32 v[34:35], v[38:39], v[38:39] op_sel:[1,1] op_sel_hi:[1,0]
  v_pk_mul_f32 v[58:59], v[62:63], v[62:63] op_sel:[1,1] op_sel_hi:[1,0]
  v_pk_fma_f32 v[38:39], v[38:39], v[38:39], v[34:35] op_sel:[0,0,0] op_sel_hi:[0,1,1] neg_lo:[0,0,1]
  v_pk_fma_f32 v[62:63], v[62:63], v[62:63], v[58:59] op_sel:[0,0,0] op_sel_hi:[0,1,1] neg_lo:[0,0,1]
  v_cvt_pk_f16_f32 v80, v40, v41
  v_cvt_pk_f16_f32 v81, v64, v65
  v_pk_mul_f32 v[34:35], v[38:39], v[28:29] op_sel:[1,1] op_sel_hi:[1,0]
  v_pk_mul_f32 v[58:59], v[62:63], v[52:53] op_sel:[1,1] op_sel_hi:[1,0]
  v_pk_fma_f32 v[40:41], v[38:39], v[28:29], v[34:35] op_sel:[0,0,0] op_sel_hi:[0,1,1] neg_lo:[0,0,1]
  v_pk_fma_f32 v[64:65], v[62:63], v[52:53], v[58:59] op_sel:[0,0,0] op_sel_hi:[0,1,1] neg_lo:[0,0,1]
  v_pk_mul_f32 v[34:35], v[38:39], v[38:39] op_sel:[1,1] op_sel_hi:[1,0]
  v_pk_mul_f32 v[58:59], v[62:63], v[62:63] op_sel:[1,1] op_sel_hi:[1,0]
  v_pk_fma_f32 v[38:39], v[38:39], v[38:39], v[34:35] op_sel:[0,0,0] op_sel_hi:[0,1,1] neg_lo:[0,0,1]
  v_pk_fma_f32 v[62:63], v[62:63], v[62:63], v[58:59] op_sel:[0,0,0] op_sel_hi:[0,1,1] neg_lo:[0,0,1]
  v_cvt_pk_f16_f32 v84, v40, v41
  v_cvt_pk_f16_f32 v85, v64, v65
  v_pk_mul_f32 v[34:35], v[38:39], v[30:31] op_sel:[1,1] op_sel_hi:[1,0]
  v_pk_mul_f32 v[58:59], v[62:63], v[54:55] op_sel:[1,1] op_sel_hi:[1,0]
  v_pk_fma_f32 v[40:41], v[38:39], v[30:31], v[34:35] op_sel:[0,0,0] op_sel_hi:[0,1,1] neg_lo:[0,0,1]
  v_pk_fma_f32 v[64:65], v[62:63], v[54:55], v[58:59] op_sel:[0,0,0] op_sel_hi:[0,1,1] neg_lo:[0,0,1]
  v_cvt_pk_f16_f32 v88, v40, v41
  v_cvt_pk_f16_f32 v89, v64, v65
  ds_read_b128 v[20:23], v1 offset:10848
  ds_read_b128 v[24:27], v1 offset:10864
  ds_read_b128 v[28:31], v1 offset:10880
  ds_read_b128 v[44:47], v1 offset:10896
  ds_read_b128 v[48:51], v1 offset:10912
  ds_read_b128 v[52:55], v1 offset:10928
  s_waitcnt lgkmcnt(0)
  v_pk_mul_f32 v[32:33], v[20:21], v[14:15] op_sel_hi:[1,0]
  v_pk_mul_f32 v[56:57], v[44:45], v[14:15] op_sel_hi:[1,0]
  v_mul_f32 v32, 0xbfb8aa3b, v32
  v_mul_f32 v56, 0xbfb8aa3b, v56
  v_mul_f32 v33, 0xbe22f983, v33
  v_mul_f32 v57, 0xbe22f983, v57
  v_exp_f32 v32, v32
  v_exp_f32 v56, v56
  v_fract_f32 v33, v33
  v_fract_f32 v57, v57
  v_cos_f32 v36, v33
  v_cos_f32 v60, v57
  v_sin_f32 v37, v33
  v_sin_f32 v61, v57
  s_nop 0
  s_nop 0
  v_pk_mul_f32 v[36:37], v[36:37], v[32:33] op_sel_hi:[1,0]
  v_pk_mul_f32 v[60:61], v[60:61], v[56:57] op_sel_hi:[1,0]
  v_cvt_pk_f16_f32 v94, v36, v37
  v_cvt_pk_f16_f32 v95, v60, v61
  v_pk_mul_f32 v[34:35], v[36:37], v[36:37] op_sel:[1,1] op_sel_hi:[1,0]
  v_pk_mul_f32 v[58:59], v[60:61], v[60:61] op_sel:[1,1] op_sel_hi:[1,0]
  v_pk_fma_f32 v[36:37], v[36:37], v[36:37], v[34:35] op_sel:[0,0,0] op_sel_hi:[0,1,1] neg_lo:[0,0,1]
  v_pk_fma_f32 v[60:61], v[60:61], v[60:61], v[58:59] op_sel:[0,0,0] op_sel_hi:[0,1,1] neg_lo:[0,0,1]
  v_cvt_pk_f16_f32 v98, v36, v37
  v_cvt_pk_f16_f32 v99, v60, v61
  v_pk_mul_f32 v[34:35], v[36:37], v[36:37] op_sel:[1,1] op_sel_hi:[1,0]
  v_pk_mul_f32 v[58:59], v[60:61], v[60:61] op_sel:[1,1] op_sel_hi:[1,0]
  v_pk_fma_f32 v[36:37], v[36:37], v[36:37], v[34:35] op_sel:[0,0,0] op_sel_hi:[0,1,1] neg_lo:[0,0,1]
  v_pk_fma_f32 v[60:61], v[60:61], v[60:61], v[58:59] op_sel:[0,0,0] op_sel_hi:[0,1,1] neg_lo:[0,0,1]
  v_cvt_pk_f16_f32 v102, v36, v37
  v_cvt_pk_f16_f32 v103, v60, v61
  v_pk_mul_f32 v[34:35], v[36:37], v[36:37] op_sel:[1,1] op_sel_hi:[1,0]
  v_pk_mul_f32 v[58:59], v[60:61], v[60:61] op_sel:[1,1] op_sel_hi:[1,0]
  v_pk_fma_f32 v[36:37], v[36:37], v[36:37], v[34:35] op_sel:[0,0,0] op_sel_hi:[0,1,1] neg_lo:[0,0,1]
  v_pk_fma_f32 v[60:61], v[60:61], v[60:61], v[58:59] op_sel:[0,0,0] op_sel_hi:[0,1,1] neg_lo:[0,0,1]
  v_cvt_pk_f16_f32 v106, v36, v37
  v_cvt_pk_f16_f32 v107, v60, v61
  v_pk_mul_f32 v[34:35], v[36:37], v[36:37] op_sel:[1,1] op_sel_hi:[1,0]
  v_pk_mul_f32 v[58:59], v[60:61], v[60:61] op_sel:[1,1] op_sel_hi:[1,0]
  v_pk_fma_f32 v[38:39], v[36:37], v[36:37], v[34:35] op_sel:[0,0,0] op_sel_hi:[0,1,1] neg_lo:[0,0,1]
  v_pk_fma_f32 v[62:63], v[60:61], v[60:61], v[58:59] op_sel:[0,0,0] op_sel_hi:[0,1,1] neg_lo:[0,0,1]
  v_xor_b32 v39, 0x80000000, v39
  v_xor_b32 v63, 0x80000000, v63
  v_pk_mul_f32 v[34:35], v[38:39], v[24:25] op_sel:[1,1] op_sel_hi:[1,0]
  v_pk_mul_f32 v[58:59], v[62:63], v[48:49] op_sel:[1,1] op_sel_hi:[1,0]
  v_pk_fma_f32 v[40:41], v[38:39], v[24:25], v[34:35] op_sel:[0,0,0] op_sel_hi:[0,1,1] neg_lo:[0,0,1]
  v_pk_fma_f32 v[64:65], v[62:63], v[48:49], v[58:59] op_sel:[0,0,0] op_sel_hi:[0,1,1] neg_lo:[0,0,1]
  v_pk_mul_f32 v[34:35], v[38:39], v[38:39] op_sel:[1,1] op_sel_hi:[1,0]
  v_pk_mul_f32 v[58:59], v[62:63], v[62:63] op_sel:[1,1] op_sel_hi:[1,0]
  v_pk_fma_f32 v[38:39], v[38:39], v[38:39], v[34:35] op_sel:[0,0,0] op_sel_hi:[0,1,1] neg_lo:[0,0,1]
  v_pk_fma_f32 v[62:63], v[62:63], v[62:63], v[58:59] op_sel:[0,0,0] op_sel_hi:[0,1,1] neg_lo:[0,0,1]
  v_cvt_pk_f16_f32 v78, v40, v41
  v_cvt_pk_f16_f32 v79, v64, v65
  v_pk_mul_f32 v[34:35], v[38:39], v[26:27] op_sel:[1,1] op_sel_hi:[1,0]
  v_pk_mul_f32 v[58:59], v[62:63], v[50:51] op_sel:[1,1] op_sel_hi:[1,0]
  v_pk_fma_f32 v[40:41], v[38:39], v[26:27], v[34:35] op_sel:[0,0,0] op_sel_hi:[0,1,1] neg_lo:[0,0,1]
  v_pk_fma_f32 v[64:65], v[62:63], v[50:51], v[58:59] op_sel:[0,0,0] op_sel_hi:[0,1,1] neg_lo:[0,0,1]
  v_pk_mul_f32 v[34:35], v[38:39], v[38:39] op_sel:[1,1] op_sel_hi:[1,0]
  v_pk_mul_f32 v[58:59], v[62:63], v[62:63] op_sel:[1,1] op_sel_hi:[1,0]
  v_pk_fma_f32 v[38:39], v[38:39], v[38:39], v[34:35] op_sel:[0,0,0] op_sel_hi:[0,1,1] neg_lo:[0,0,1]
  v_pk_fma_f32 v[62:63], v[62:63], v[62:63], v[58:59] op_sel:[0,0,0] op_sel_hi:[0,1,1] neg_lo:[0,0,1]
  v_cvt_pk_f16_f32 v82, v40, v41
  v_cvt_pk_f16_f32 v83, v64, v65
  v_pk_mul_f32 v[34:35], v[38:39], v[28:29] op_sel:[1,1] op_sel_hi:[1,0]
  v_pk_mul_f32 v[58:59], v[62:63], v[52:53] op_sel:[1,1] op_sel_hi:[1,0]
  v_pk_fma_f32 v[40:41], v[38:39], v[28:29], v[34:35] op_sel:[0,0,0] op_sel_hi:[0,1,1] neg_lo:[0,0,1]
  v_pk_fma_f32 v[64:65], v[62:63], v[52:53], v[58:59] op_sel:[0,0,0] op_sel_hi:[0,1,1] neg_lo:[0,0,1]
  v_pk_mul_f32 v[34:35], v[38:39], v[38:39] op_sel:[1,1] op_sel_hi:[1,0]
  v_pk_mul_f32 v[58:59], v[62:63], v[62:63] op_sel:[1,1] op_sel_hi:[1,0]
  v_pk_fma_f32 v[38:39], v[38:39], v[38:39], v[34:35] op_sel:[0,0,0] op_sel_hi:[0,1,1] neg_lo:[0,0,1]
  v_pk_fma_f32 v[62:63], v[62:63], v[62:63], v[58:59] op_sel:[0,0,0] op_sel_hi:[0,1,1] neg_lo:[0,0,1]
  v_cvt_pk_f16_f32 v86, v40, v41
  v_cvt_pk_f16_f32 v87, v64, v65
  v_pk_mul_f32 v[34:35], v[38:39], v[30:31] op_sel:[1,1] op_sel_hi:[1,0]
  v_pk_mul_f32 v[58:59], v[62:63], v[54:55] op_sel:[1,1] op_sel_hi:[1,0]
  v_pk_fma_f32 v[40:41], v[38:39], v[30:31], v[34:35] op_sel:[0,0,0] op_sel_hi:[0,1,1] neg_lo:[0,0,1]
  v_pk_fma_f32 v[64:65], v[62:63], v[54:55], v[58:59] op_sel:[0,0,0] op_sel_hi:[0,1,1] neg_lo:[0,0,1]
  v_cvt_pk_f16_f32 v90, v40, v41
  v_cvt_pk_f16_f32 v91, v64, v65
  s_nop 1
  v_mfma_f32_16x16x32_f16 v[108:111], v[76:79], v[92:95], v[108:111]
  v_mfma_f32_16x16x32_f16 v[112:115], v[80:83], v[96:99], v[112:115]
  v_mfma_f32_16x16x32_f16 v[116:119], v[84:87], v[100:103], v[116:119]
  v_mfma_f32_16x16x32_f16 v[120:123], v[88:91], v[104:107], v[120:123]
  s_nop 7
  s_nop 1
  v_mul_f32 v108, s66, v108
  v_mul_f32 v109, s66, v109
  v_mul_f32 v110, s66, v110
  v_mul_f32 v111, s66, v111
  v_mul_f32 v112, s66, v112
  v_mul_f32 v113, s66, v113
  v_mul_f32 v114, s66, v114
  v_mul_f32 v115, s66, v115
  v_mul_f32 v116, s66, v116
  v_mul_f32 v117, s66, v117
  v_mul_f32 v118, s66, v118
  v_mul_f32 v119, s66, v119
  v_mul_f32 v120, s66, v120
  v_mul_f32 v121, s66, v121
  v_mul_f32 v122, s66, v122
  v_mul_f32 v123, s66, v123
  s_nop 7
  s_nop 3
  v_lshlrev_b32 v15, 8, v13
  v_lshl_add_u32 v15, v12, 2, v15
  v_add_u32 v15, v15, v10
  ds_write_b32 v15, v108 offset:0
  ds_write_b32 v15, v109 offset:64
  ds_write_b32 v15, v110 offset:128
  ds_write_b32 v15, v111 offset:192
  ds_write_b32 v15, v112 offset:1024
  ds_write_b32 v15, v113 offset:1088
  ds_write_b32 v15, v114 offset:1152
  ds_write_b32 v15, v115 offset:1216
  ds_write_b32 v15, v116 offset:2048
  ds_write_b32 v15, v117 offset:2112
  ds_write_b32 v15, v118 offset:2176
  ds_write_b32 v15, v119 offset:2240
  ds_write_b32 v15, v120 offset:3072
  ds_write_b32 v15, v121 offset:3136
  ds_write_b32 v15, v122 offset:3200
  ds_write_b32 v15, v123 offset:3264
  v_cmp_eq_u32 vcc, 32, v8
  v_add_u32 v16, 4096, v10
  v_add_u32 v17, 4100, v10
  s_nop 0
  v_cndmask_b32 v16, v17, v16, vcc
  ds_write_b32 v16, v120
  s_waitcnt lgkmcnt(0)
  s_barrier
  v_lshlrev_b32 v1, 4, v0
  v_add_u32 v2, 0, v1
  v_cvt_f32_u32 v3, v2
  v_cvt_pk_bf16_f32 v3, v3, v3
  v_bfe_u32 v4, v3, 7, 9
  v_and_b32 v3, 127, v3
  v_lshl_add_u32 v3, v4, 8, v3
  v_subrev_u32 v3, 34304, v3
  v_cmp_gt_u32 vcc, 256, v2
  s_nop 1
  v_cndmask_b32 v3, v3, v2, vcc
  v_lshlrev_b32 v3, 2, v3
  ds_read_b32 v32, v3
  ds_read_b32 v48, v3 offset:4160
  v_add_u32 v2, 1, v1
  v_cvt_f32_u32 v3, v2
  v_cvt_pk_bf16_f32 v3, v3, v3
  v_bfe_u32 v4, v3, 7, 9
  v_and_b32 v3, 127, v3
  v_lshl_add_u32 v3, v4, 8, v3
  v_subrev_u32 v3, 34304, v3
  v_cmp_gt_u32 vcc, 256, v2
  s_nop 1
  v_cndmask_b32 v3, v3, v2, vcc
  v_lshlrev_b32 v3, 2, v3
  ds_read_b32 v33, v3
  ds_read_b32 v49, v3 offset:4160
  v_add_u32 v2, 2, v1
  v_cvt_f32_u32 v3, v2
  v_cvt_pk_bf16_f32 v3, v3, v3
  v_bfe_u32 v4, v3, 7, 9
  v_and_b32 v3, 127, v3
  v_lshl_add_u32 v3, v4, 8, v3
  v_subrev_u32 v3, 34304, v3
  v_cmp_gt_u32 vcc, 256, v2
  s_nop 1
  v_cndmask_b32 v3, v3, v2, vcc
  v_lshlrev_b32 v3, 2, v3
  ds_read_b32 v34, v3
  ds_read_b32 v50, v3 offset:4160
  v_add_u32 v2, 3, v1
  v_cvt_f32_u32 v3, v2
  v_cvt_pk_bf16_f32 v3, v3, v3
  v_bfe_u32 v4, v3, 7, 9
  v_and_b32 v3, 127, v3
  v_lshl_add_u32 v3, v4, 8, v3
  v_subrev_u32 v3, 34304, v3
  v_cmp_gt_u32 vcc, 256, v2
  s_nop 1
  v_cndmask_b32 v3, v3, v2, vcc
  v_lshlrev_b32 v3, 2, v3
  ds_read_b32 v35, v3
  ds_read_b32 v51, v3 offset:4160
  v_add_u32 v2, 4, v1
  v_cvt_f32_u32 v3, v2
  v_cvt_pk_bf16_f32 v3, v3, v3
  v_bfe_u32 v4, v3, 7, 9
  v_and_b32 v3, 127, v3
  v_lshl_add_u32 v3, v4, 8, v3
  v_subrev_u32 v3, 34304, v3
  v_cmp_gt_u32 vcc, 256, v2
  s_nop 1
  v_cndmask_b32 v3, v3, v2, vcc
  v_lshlrev_b32 v3, 2, v3
  ds_read_b32 v36, v3
  ds_read_b32 v52, v3 offset:4160
  v_add_u32 v2, 5, v1
  v_cvt_f32_u32 v3, v2
  v_cvt_pk_bf16_f32 v3, v3, v3
  v_bfe_u32 v4, v3, 7, 9
  v_and_b32 v3, 127, v3
  v_lshl_add_u32 v3, v4, 8, v3
  v_subrev_u32 v3, 34304, v3
  v_cmp_gt_u32 vcc, 256, v2
  s_nop 1
  v_cndmask_b32 v3, v3, v2, vcc
  v_lshlrev_b32 v3, 2, v3
  ds_read_b32 v37, v3
  ds_read_b32 v53, v3 offset:4160
  v_add_u32 v2, 6, v1
  v_cvt_f32_u32 v3, v2
  v_cvt_pk_bf16_f32 v3, v3, v3
  v_bfe_u32 v4, v3, 7, 9
  v_and_b32 v3, 127, v3
  v_lshl_add_u32 v3, v4, 8, v3
  v_subrev_u32 v3, 34304, v3
  v_cmp_gt_u32 vcc, 256, v2
  s_nop 1
  v_cndmask_b32 v3, v3, v2, vcc
  v_lshlrev_b32 v3, 2, v3
  ds_read_b32 v38, v3
  ds_read_b32 v54, v3 offset:4160
  v_add_u32 v2, 7, v1
  v_cvt_f32_u32 v3, v2
  v_cvt_pk_bf16_f32 v3, v3, v3
  v_bfe_u32 v4, v3, 7, 9
  v_and_b32 v3, 127, v3
  v_lshl_add_u32 v3, v4, 8, v3
  v_subrev_u32 v3, 34304, v3
  v_cmp_gt_u32 vcc, 256, v2
  s_nop 1
  v_cndmask_b32 v3, v3, v2, vcc
  v_lshlrev_b32 v3, 2, v3
  ds_read_b32 v39, v3
  ds_read_b32 v55, v3 offset:4160
  v_add_u32 v2, 8, v1
  v_cvt_f32_u32 v3, v2
  v_cvt_pk_bf16_f32 v3, v3, v3
  v_bfe_u32 v4, v3, 7, 9
  v_and_b32 v3, 127, v3
  v_lshl_add_u32 v3, v4, 8, v3
  v_subrev_u32 v3, 34304, v3
  v_cmp_gt_u32 vcc, 256, v2
  s_nop 1
  v_cndmask_b32 v3, v3, v2, vcc
  v_lshlrev_b32 v3, 2, v3
  ds_read_b32 v40, v3
  ds_read_b32 v56, v3 offset:4160
  v_add_u32 v2, 9, v1
  v_cvt_f32_u32 v3, v2
  v_cvt_pk_bf16_f32 v3, v3, v3
  v_bfe_u32 v4, v3, 7, 9
  v_and_b32 v3, 127, v3
  v_lshl_add_u32 v3, v4, 8, v3
  v_subrev_u32 v3, 34304, v3
  v_cmp_gt_u32 vcc, 256, v2
  s_nop 1
  v_cndmask_b32 v3, v3, v2, vcc
  v_lshlrev_b32 v3, 2, v3
  ds_read_b32 v41, v3
  ds_read_b32 v57, v3 offset:4160
  v_add_u32 v2, 10, v1
  v_cvt_f32_u32 v3, v2
  v_cvt_pk_bf16_f32 v3, v3, v3
  v_bfe_u32 v4, v3, 7, 9
  v_and_b32 v3, 127, v3
  v_lshl_add_u32 v3, v4, 8, v3
  v_subrev_u32 v3, 34304, v3
  v_cmp_gt_u32 vcc, 256, v2
  s_nop 1
  v_cndmask_b32 v3, v3, v2, vcc
  v_lshlrev_b32 v3, 2, v3
  ds_read_b32 v42, v3
  ds_read_b32 v58, v3 offset:4160
  v_add_u32 v2, 11, v1
  v_cvt_f32_u32 v3, v2
  v_cvt_pk_bf16_f32 v3, v3, v3
  v_bfe_u32 v4, v3, 7, 9
  v_and_b32 v3, 127, v3
  v_lshl_add_u32 v3, v4, 8, v3
  v_subrev_u32 v3, 34304, v3
  v_cmp_gt_u32 vcc, 256, v2
  s_nop 1
  v_cndmask_b32 v3, v3, v2, vcc
  v_lshlrev_b32 v3, 2, v3
  ds_read_b32 v43, v3
  ds_read_b32 v59, v3 offset:4160
  v_add_u32 v2, 12, v1
  v_cvt_f32_u32 v3, v2
  v_cvt_pk_bf16_f32 v3, v3, v3
  v_bfe_u32 v4, v3, 7, 9
  v_and_b32 v3, 127, v3
  v_lshl_add_u32 v3, v4, 8, v3
  v_subrev_u32 v3, 34304, v3
  v_cmp_gt_u32 vcc, 256, v2
  s_nop 1
  v_cndmask_b32 v3, v3, v2, vcc
  v_lshlrev_b32 v3, 2, v3
  ds_read_b32 v44, v3
  ds_read_b32 v60, v3 offset:4160
  v_add_u32 v2, 13, v1
  v_cvt_f32_u32 v3, v2
  v_cvt_pk_bf16_f32 v3, v3, v3
  v_bfe_u32 v4, v3, 7, 9
  v_and_b32 v3, 127, v3
  v_lshl_add_u32 v3, v4, 8, v3
  v_subrev_u32 v3, 34304, v3
  v_cmp_gt_u32 vcc, 256, v2
  s_nop 1
  v_cndmask_b32 v3, v3, v2, vcc
  v_lshlrev_b32 v3, 2, v3
  ds_read_b32 v45, v3
  ds_read_b32 v61, v3 offset:4160
  v_add_u32 v2, 14, v1
  v_cvt_f32_u32 v3, v2
  v_cvt_pk_bf16_f32 v3, v3, v3
  v_bfe_u32 v4, v3, 7, 9
  v_and_b32 v3, 127, v3
  v_lshl_add_u32 v3, v4, 8, v3
  v_subrev_u32 v3, 34304, v3
  v_cmp_gt_u32 vcc, 256, v2
  s_nop 1
  v_cndmask_b32 v3, v3, v2, vcc
  v_lshlrev_b32 v3, 2, v3
  ds_read_b32 v46, v3
  ds_read_b32 v62, v3 offset:4160
  v_add_u32 v2, 15, v1
  v_cvt_f32_u32 v3, v2
  v_cvt_pk_bf16_f32 v3, v3, v3
  v_bfe_u32 v4, v3, 7, 9
  v_and_b32 v3, 127, v3
  v_lshl_add_u32 v3, v4, 8, v3
  v_subrev_u32 v3, 34304, v3
  v_cmp_gt_u32 vcc, 256, v2
  s_nop 1
  v_cndmask_b32 v3, v3, v2, vcc
  v_lshlrev_b32 v3, 2, v3
  ds_read_b32 v47, v3
  ds_read_b32 v63, v3 offset:4160
  s_waitcnt lgkmcnt(0)
  v_add_f32 v32, v32, v48
  v_add_f32 v33, v33, v49
  v_add_f32 v34, v34, v50
  v_add_f32 v35, v35, v51
  v_add_f32 v36, v36, v52
  v_add_f32 v37, v37, v53
  v_add_f32 v38, v38, v54
  v_add_f32 v39, v39, v55
  v_add_f32 v40, v40, v56
  v_add_f32 v41, v41, v57
  v_add_f32 v42, v42, v58
  v_add_f32 v43, v43, v59
  v_add_f32 v44, v44, v60
  v_add_f32 v45, v45, v61
  v_add_f32 v46, v46, v62
  v_add_f32 v47, v47, v63
  v_cvt_pk_bf16_f32 v64, v32, v33
  v_cvt_pk_bf16_f32 v65, v34, v35
  v_cvt_pk_bf16_f32 v66, v36, v37
  v_cvt_pk_bf16_f32 v67, v38, v39
  v_cvt_pk_bf16_f32 v68, v40, v41
  v_cvt_pk_bf16_f32 v69, v42, v43
  v_cvt_pk_bf16_f32 v70, v44, v45
  v_cvt_pk_bf16_f32 v71, v46, v47
  s_lshl_b32 s3, s2, 12
  v_lshlrev_b32 v1, 5, v0
  v_add_u32 v1, s3, v1
  buffer_store_dwordx4 v[64:67], v1, s[60:63], 0 offen
  buffer_store_dwordx4 v[68:71], v1, s[60:63], 0 offen offset:16
L_k1_end:
  s_endpgm
.globl conv_kernel
.p2align 8
.type conv_kernel,@function
conv_kernel:
  s_cmp_ge_u32 s2, 256
  s_cbranch_scc1 L_k2_end
  s_load_dwordx16 s[8:23], s[0:1], 0
  s_load_dwordx16 s[24:39], s[0:1], 64
  s_waitcnt lgkmcnt(0)
  s_and_b32 s3, s2, 7
  s_lshr_b32 s40, s2, 3
  s_lshr_b32 s41, s40, 4
  s_and_b32 s40, s40, 15
  s_lshl_b32 s42, s3, 7
  s_lshl_b32 s40, s40, 3
  s_add_u32 s42, s42, s40
  s_lshl_b32 s3, s41, 22
  s_add_u32 s44, s38, s3
  s_addc_u32 s45, s39, 0
  s_and_b32 s45, s45, 0xffff
  s_mov_b32 s46, 0x400000
  s_mov_b32 s47, 0x00020000
  s_add_u32 s48, s38, 0xc00000
  s_addc_u32 s49, s39, 0
  s_cmp_eq_u32 s41, 0
  s_cselect_b32 s48, s48, s30
  s_cselect_b32 s49, s49, s31
  s_and_b32 s49, s49, 0xffff
  s_mov_b32 s50, 0x400000
  s_mov_b32 s51, 0x00020000
  s_add_u32 s52, s38, 0x800000
  s_addc_u32 s53, s39, 0
  s_and_b32 s53, s53, 0xffff
  s_mov_b32 s54, 0x400000
  s_mov_b32 s55, 0x00020000
  s_cmp_eq_u32 s41, 0
  s_cselect_b32 s56, s20, s32
  s_cselect_b32 s57, s21, s33
  s_and_b32 s57, s57, 0xffff
  s_mov_b32 s58, 2048
  s_mov_b32 s59, 0x00020000
  s_mov_b32 s60, s34
  s_and_b32 s61, s35, 0xffff
  s_mov_b32 s62, 0x800000
  s_mov_b32 s63, 0x00020000
  s_mov_b32 s64, 0xffff0000
  s_mov_b32 s65, 0x0000ffff
  s_mov_b32 s70, s42
  s_mov_b32 s71, 0
  s_mov_b32 s72, 35328
  s_mov_b32 s73, 9072
  v_mov_b32 v229, v0
  v_lshrrev_b32 v2, 6, v0
  s_nop 0
  v_readfirstlane_b32 s75, v2
  v_and_b32 v0, 255, v0
  v_and_b32 v1, 63, v0
  v_bfe_u32 v2, v0, 6, 2
  v_and_b32 v3, 31, v0
  v_bfe_u32 v4, v0, 5, 1
  s_cmp_ge_u32 s75, 4
  s_cbranch_scc1 L_k2_helper
  v_and_b32 v14, 7, v3
  v_sub_u32 v14, 7, v14
  v_mul_u32_u24 v5, 4416, v14
  v_lshrrev_b32 v14, 3, v3
  v_sub_u32 v14, v4, v14
  v_lshlrev_b32 v14, 4, v14
  v_add_u32 v5, v5, v14
  v_add_u32 v5, 3120, v5
  v_lshlrev_b32 v14, 10, v2
  v_sub_u32 v5, v5, v14
  v_lshlrev_b32 v14, 3, v2
  v_sub_u32 v14, v3, v14
  v_add_u32 v14, 24, v14
  v_mul_u32_u24 v6, 144, v14
  v_lshl_add_u32 v6, v4, 4, v6
  v_add_u32 v6, 70656, v6
  v_lshlrev_b32 v10, 11, v2
  v_lshl_add_u32 v10, v1, 4, v10
  v_add_u32 v10, 88800, v10
  s_barrier
  v_add_u32 v15, 35328, v5
  v_add_u32 v16, 9072, v6
  ds_read_b128 v[160:163], v6 offset:1008
  ds_read_b128 v[108:111], v5 offset:960
  ds_read_b128 v[116:119], v5 offset:896
  ds_read_b128 v[164:167], v6 offset:1040
  ds_read_b128 v[104:107], v5 offset:992
  ds_read_b128 v[112:115], v5 offset:928
  ds_read_b128 v[168:171], v6 offset:1072
  ds_read_b128 v[100:103], v5 offset:1024
  ds_read_b128 v[172:175], v6 offset:1104
  ds_read_b128 v[96:99], v5 offset:1056
  s_waitcnt lgkmcnt(8)
  v_mfma_f32_32x32x16_bf16 v[32:47], v[108:111], v[160:163], 0
  ds_read_b128 v[176:179], v6 offset:864
  s_waitcnt lgkmcnt(8)
  v_mfma_f32_32x32x16_bf16 v[48:63], v[116:119], v[160:163], 0
  ds_read_b128 v[124:127], v5 offset:832
  s_waitcnt lgkmcnt(7)
  v_mfma_f32_32x32x16_bf16 v[32:47], v[104:107], v[164:167], v[32:47]
  ds_read_b128 v[132:135], v5 offset:768
  s_waitcnt lgkmcnt(7)
  v_mfma_f32_32x32x16_bf16 v[48:63], v[112:115], v[164:167], v[48:63]
  ds_read_b128 v[180:183], v6 offset:896
  s_waitcnt lgkmcnt(6)
  v_mfma_f32_32x32x16_bf16 v[32:47], v[100:103], v[168:171], v[32:47]
  ds_read_b128 v[120:123], v5 offset:864
  v_mfma_f32_32x32x16_bf16 v[48:63], v[108:111], v[168:171], v[48:63]
  ds_read_b128 v[128:131], v5 offset:800
  s_waitcnt lgkmcnt(6)
  v_mfma_f32_32x32x16_bf16 v[32:47], v[96:99], v[172:175], v[32:47]
  ds_read_b128 v[184:187], v6 offset:928
  v_mfma_f32_32x32x16_bf16 v[48:63], v[104:107], v[172:175], v[48:63]
  ds_read_b128 v[188:191], v6 offset:960
  s_waitcnt lgkmcnt(6)
  v_mfma_f32_32x32x16_bf16 v[32:47], v[124:127], v[176:179], v[32:47]
  ds_read_b128 v[160:163], v6 offset:720
  s_waitcnt lgkmcnt(6)
  v_mfma_f32_32x32x16_bf16 v[48:63], v[132:135], v[176:179], v[48:63]
  ds_read_b128 v[140:143], v5 offset:704
  s_waitcnt lgkmcnt(5)
  v_mfma_f32_32x32x16_bf16 v[32:47], v[120:123], v[180:183], v[32:47]
  ds_read_b128 v[148:151], v5 offset:640
  s_waitcnt lgkmcnt(5)
  v_mfma_f32_32x32x16_bf16 v[48:63], v[128:131], v[180:183], v[48:63]
  ds_read_b128 v[164:167], v6 offset:752
  s_waitcnt lgkmcnt(5)
  v_mfma_f32_32x32x16_bf16 v[32:47], v[116:119], v[184:187], v[32:47]
  ds_read_b128 v[136:139], v5 offset:736
  v_mfma_f32_32x32x16_bf16 v[48:63], v[124:127], v[184:187], v[48:63]
  ds_read_b128 v[144:147], v5 offset:672
  s_waitcnt lgkmcnt(6)
  v_mfma_f32_32x32x16_bf16 v[32:47], v[112:115], v[188:191], v[32:47]
  ds_read_b128 v[168:171], v6 offset:784
  v_mfma_f32_32x32x16_bf16 v[48:63], v[120:123], v[188:191], v[48:63]
  ds_read_b128 v[172:175], v6 offset:816
  s_waitcnt lgkmcnt(6)
  v_mfma_f32_32x32x16_bf16 v[32:47], v[140:143], v[160:163], v[32:47]
  ds_read_b128 v[176:179], v6 offset:576
  s_waitcnt lgkmcnt(6)
  v_mfma_f32_32x32x16_bf16 v[48:63], v[148:151], v[160:163], v[48:63]
  ds_read_b128 v[156:159], v5 offset:576
  s_waitcnt lgkmcnt(5)
  v_mfma_f32_32x32x16_bf16 v[32:47], v[136:139], v[164:167], v[32:47]
  ds_read_b128 v[100:103], v5 offset:512
  s_waitcnt lgkmcnt(5)
  v_mfma_f32_32x32x16_bf16 v[48:63], v[144:147], v[164:167], v[48:63]
  ds_read_b128 v[180:183], v6 offset:608
  s_waitcnt lgkmcnt(5)
  v_mfma_f32_32x32x16_bf16 v[32:47], v[132:135], v[168:171], v[32:47]
  ds_read_b128 v[152:155], v5 offset:608
  v_mfma_f32_32x32x16_bf16 v[48:63], v[140:143], v[168:171], v[48:63]
  ds_read_b128 v[96:99], v5 offset:544
  s_waitcnt lgkmcnt(6)
  v_mfma_f32_32x32x16_bf16 v[32:47], v[128:131], v[172:175], v[32:47]
  ds_read_b128 v[184:187], v6 offset:640
  v_mfma_f32_32x32x16_bf16 v[48:63], v[136:139], v[172:175], v[48:63]
  ds_read_b128 v[188:191], v6 offset:672
  s_waitcnt lgkmcnt(6)
  v_mfma_f32_32x32x16_bf16 v[32:47], v[156:159], v[176:179], v[32:47]
  ds_read_b128 v[160:163], v6 offset:432
  s_waitcnt lgkmcnt(6)
  v_mfma_f32_32x32x16_bf16 v[48:63], v[100:103], v[176:179], v[48:63]
  ds_read_b128 v[108:111], v5 offset:448
  s_waitcnt lgkmcnt(5)
  v_mfma_f32_32x32x16_bf16 v[32:47], v[152:155], v[180:183], v[32:47]
  ds_read_b128 v[116:119], v5 offset:384
  s_waitcnt lgkmcnt(5)
  v_mfma_f32_32x32x16_bf16 v[48:63], v[96:99], v[180:183], v[48:63]
  ds_read_b128 v[164:167], v6 offset:464
  s_waitcnt lgkmcnt(5)
  v_mfma_f32_32x32x16_bf16 v[32:47], v[148:151], v[184:187], v[32:47]
  ds_read_b128 v[104:107], v5 offset:480
  v_mfma_f32_32x32x16_bf16 v[48:63], v[156:159], v[184:187], v[48:63]
  ds_read_b128 v[112:115], v5 offset:416
  s_waitcnt lgkmcnt(6)
  v_mfma_f32_32x32x16_bf16 v[32:47], v[144:147], v[188:191], v[32:47]
  ds_read_b128 v[168:171], v6 offset:496
  v_mfma_f32_32x32x16_bf16 v[48:63], v[152:155], v[188:191], v[48:63]
  ds_read_b128 v[172:175], v6 offset:528
  s_barrier
  s_waitcnt lgkmcnt(6)
  v_mfma_f32_32x32x16_bf16 v[32:47], v[108:111], v[160:163], v[32:47]
  ds_read_b128 v[176:179], v6 offset:288
  s_waitcnt lgkmcnt(6)
  v_mfma_f32_32x32x16_bf16 v[48:63], v[116:119], v[160:163], v[48:63]
  ds_read_b128 v[124:127], v5 offset:320
  s_waitcnt lgkmcnt(5)
  v_mfma_f32_32x32x16_bf16 v[32:47], v[104:107], v[164:167], v[32:47]
  ds_read_b128 v[132:135], v5 offset:256
  s_waitcnt lgkmcnt(5)
  v_mfma_f32_32x32x16_bf16 v[48:63], v[112:115], v[164:167], v[48:63]
  ds_read_b128 v[180:183], v6 offset:320
  s_waitcnt lgkmcnt(5)
  v_mfma_f32_32x32x16_bf16 v[32:47], v[100:103], v[168:171], v[32:47]
  ds_read_b128 v[120:123], v5 offset:352
  v_mfma_f32_32x32x16_bf16 v[48:63], v[108:111], v[168:171], v[48:63]
  ds_read_b128 v[128:131], v5 offset:288
  s_waitcnt lgkmcnt(6)
  v_mfma_f32_32x32x16_bf16 v[32:47], v[96:99], v[172:175], v[32:47]
  ds_read_b128 v[184:187], v6 offset:352
  v_mfma_f32_32x32x16_bf16 v[48:63], v[104:107], v[172:175], v[48:63]
  ds_read_b128 v[188:191], v6 offset:384
  s_waitcnt lgkmcnt(6)
  v_mfma_f32_32x32x16_bf16 v[32:47], v[124:127], v[176:179], v[32:47]
  ds_read_b128 v[160:163], v6 offset:144
  s_waitcnt lgkmcnt(6)
  v_mfma_f32_32x32x16_bf16 v[48:63], v[132:135], v[176:179], v[48:63]
  ds_read_b128 v[140:143], v5 offset:192
  s_waitcnt lgkmcnt(5)
  v_mfma_f32_32x32x16_bf16 v[32:47], v[120:123], v[180:183], v[32:47]
  ds_read_b128 v[148:151], v5 offset:128
  s_waitcnt lgkmcnt(5)
  v_mfma_f32_32x32x16_bf16 v[48:63], v[128:131], v[180:183], v[48:63]
  ds_read_b128 v[164:167], v6 offset:176
  s_waitcnt lgkmcnt(5)
  v_mfma_f32_32x32x16_bf16 v[32:47], v[116:119], v[184:187], v[32:47]
  ds_read_b128 v[136:139], v5 offset:224
  v_mfma_f32_32x32x16_bf16 v[48:63], v[124:127], v[184:187], v[48:63]
  ds_read_b128 v[144:147], v5 offset:160
  s_waitcnt lgkmcnt(6)
  v_mfma_f32_32x32x16_bf16 v[32:47], v[112:115], v[188:191], v[32:47]
  ds_read_b128 v[168:171], v6 offset:208
  v_mfma_f32_32x32x16_bf16 v[48:63], v[120:123], v[188:191], v[48:63]
  ds_read_b128 v[172:175], v6 offset:240
  s_waitcnt lgkmcnt(6)
  v_mfma_f32_32x32x16_bf16 v[32:47], v[140:143], v[160:163], v[32:47]
  ds_read_b128 v[176:179], v6 offset:0
  s_waitcnt lgkmcnt(6)
  v_mfma_f32_32x32x16_bf16 v[48:63], v[148:151], v[160:163], v[48:63]
  ds_read_b128 v[156:159], v5 offset:64
  s_waitcnt lgkmcnt(5)
  v_mfma_f32_32x32x16_bf16 v[32:47], v[136:139], v[164:167], v[32:47]
  ds_read_b128 v[100:103], v5 offset:0
  s_waitcnt lgkmcnt(5)
  v_mfma_f32_32x32x16_bf16 v[48:63], v[144:147], v[164:167], v[48:63]
  ds_read_b128 v[180:183], v6 offset:32
  s_waitcnt lgkmcnt(5)
  v_mfma_f32_32x32x16_bf16 v[32:47], v[132:135], v[168:171], v[32:47]
  ds_read_b128 v[152:155], v5 offset:96
  v_mfma_f32_32x32x16_bf16 v[48:63], v[140:143], v[168:171], v[48:63]
  ds_read_b128 v[96:99], v5 offset:32
  s_waitcnt lgkmcnt(6)
  v_mfma_f32_32x32x16_bf16 v[32:47], v[128:131], v[172:175], v[32:47]
  ds_read_b128 v[184:187], v6 offset:64
  v_mfma_f32_32x32x16_bf16 v[48:63], v[136:139], v[172:175], v[48:63]
  ds_read_b128 v[188:191], v6 offset:96
  s_waitcnt lgkmcnt(6)
  v_mfma_f32_32x32x16_bf16 v[32:47], v[156:159], v[176:179], v[32:47]
  ds_read_b128 v[160:163], v16 offset:1008
  ds_read_b128 v[116:119], v15 offset:960
  s_waitcnt lgkmcnt(7)
  v_mfma_f32_32x32x16_bf16 v[48:63], v[100:103], v[176:179], v[48:63]
  ds_read_b128 v[124:127], v15 offset:896
  s_waitcnt lgkmcnt(6)
  v_mfma_f32_32x32x16_bf16 v[32:47], v[152:155], v[180:183], v[32:47]
  ds_read_b128 v[164:167], v16 offset:1040
  s_waitcnt lgkmcnt(6)
  v_mfma_f32_32x32x16_bf16 v[48:63], v[96:99], v[180:183], v[48:63]
  ds_read_b128 v[112:115], v15 offset:992
  s_waitcnt lgkmcnt(6)
  v_mfma_f32_32x32x16_bf16 v[32:47], v[148:151], v[184:187], v[32:47]
  ds_read_b128 v[120:123], v15 offset:928
  ds_read_b128 v[168:171], v16 offset:1072
  v_mfma_f32_32x32x16_bf16 v[48:63], v[156:159], v[184:187], v[48:63]
  ds_read_b128 v[108:111], v15 offset:1024
  s_waitcnt lgkmcnt(8)
  v_mfma_f32_32x32x16_bf16 v[32:47], v[144:147], v[188:191], v[32:47]
  ds_read_b128 v[172:175], v16 offset:1104
  v_mfma_f32_32x32x16_bf16 v[48:63], v[152:155], v[188:191], v[48:63]
  ds_read_b128 v[104:107], v15 offset:1056
  s_barrier
  s_waitcnt lgkmcnt(8)
  v_mfma_f32_32x32x16_bf16 v[64:79], v[116:119], v[160:163], 0
  ds_read_b128 v[176:179], v16 offset:864
  s_waitcnt lgkmcnt(8)
  v_mfma_f32_32x32x16_bf16 v[80:95], v[124:127], v[160:163], 0
  ds_read_b128 v[132:135], v15 offset:832
  s_waitcnt lgkmcnt(7)
  v_mfma_f32_32x32x16_bf16 v[64:79], v[112:115], v[164:167], v[64:79]
  ds_read_b128 v[140:143], v15 offset:768
  s_waitcnt lgkmcnt(7)
  v_mfma_f32_32x32x16_bf16 v[80:95], v[120:123], v[164:167], v[80:95]
  ds_read_b128 v[180:183], v16 offset:896
  s_waitcnt lgkmcnt(6)
  v_mfma_f32_32x32x16_bf16 v[64:79], v[108:111], v[168:171], v[64:79]
  ds_read_b128 v[128:131], v15 offset:864
  v_mfma_f32_32x32x16_bf16 v[80:95], v[116:119], v[168:171], v[80:95]
  ds_read_b128 v[136:139], v15 offset:800
  s_waitcnt lgkmcnt(6)
  v_mfma_f32_32x32x16_bf16 v[64:79], v[104:107], v[172:175], v[64:79]
  ds_read_b128 v[184:187], v16 offset:928
  v_mfma_f32_32x32x16_bf16 v[80:95], v[112:115], v[172:175], v[80:95]
  ds_read_b128 v[188:191], v16 offset:960
  s_waitcnt lgkmcnt(6)
  v_mfma_f32_32x32x16_bf16 v[64:79], v[132:135], v[176:179], v[64:79]
  ds_read_b128 v[160:163], v16 offset:720
  ds_read_b128 v[148:151], v15 offset:704
  s_waitcnt lgkmcnt(7)
  v_mfma_f32_32x32x16_bf16 v[80:95], v[140:143], v[176:179], v[80:95]
  ds_read_b128 v[156:159], v15 offset:640
  ds_read_b128 v[164:167], v16 offset:752
  s_waitcnt lgkmcnt(7)
  v_mfma_f32_32x32x16_bf16 v[64:79], v[128:131], v[180:183], v[64:79]
  ds_read_b128 v[144:147], v15 offset:736
  ds_read_b128 v[152:155], v15 offset:672
  s_waitcnt lgkmcnt(8)
  v_mfma_f32_32x32x16_bf16 v[80:95], v[136:139], v[180:183], v[80:95]
  ds_read_b128 v[168:171], v16 offset:784
  ds_read_b128 v[172:175], v16 offset:816
  s_waitcnt lgkmcnt(9)
  v_mfma_f32_32x32x16_bf16 v[64:79], v[124:127], v[184:187], v[64:79]
  ds_write_b128 v10, v[32:35] offset:0
  ds_write_b128 v10, v[36:39] offset:1024
  v_mfma_f32_32x32x16_bf16 v[80:95], v[132:135], v[184:187], v[80:95]
  ds_write_b128 v10, v[40:43] offset:8192
  ds_write_b128 v10, v[44:47] offset:9216
  s_waitcnt lgkmcnt(12)
  v_mfma_f32_32x32x16_bf16 v[64:79], v[120:123], v[188:191], v[64:79]
  ds_write_b128 v10, v[48:51] offset:16384
  ds_write_b128 v10, v[52:55] offset:17408
  v_mfma_f32_32x32x16_bf16 v[80:95], v[128:131], v[188:191], v[80:95]
  ds_write_b128 v10, v[56:59] offset:24576
  ds_write_b128 v10, v[60:63] offset:25600
  s_waitcnt lgkmcnt(14)
  v_mfma_f32_32x32x16_bf16 v[64:79], v[148:151], v[160:163], v[64:79]
  ds_read_b128 v[176:179], v16 offset:576
  s_waitcnt lgkmcnt(14)
  v_mfma_f32_32x32x16_bf16 v[80:95], v[156:159], v[160:163], v[80:95]
  ds_read_b128 v[100:103], v15 offset:576
  s_waitcnt lgkmcnt(13)
  v_mfma_f32_32x32x16_bf16 v[64:79], v[144:147], v[164:167], v[64:79]
  ds_read_b128 v[108:111], v15 offset:512
  s_waitcnt lgkmcnt(13)
  v_mfma_f32_32x32x16_bf16 v[80:95], v[152:155], v[164:167], v[80:95]
  ds_read_b128 v[180:183], v16 offset:608
  s_waitcnt lgkmcnt(13)
  v_mfma_f32_32x32x16_bf16 v[64:79], v[140:143], v[168:171], v[64:79]
  ds_read_b128 v[96:99], v15 offset:608
  v_mfma_f32_32x32x16_bf16 v[80:95], v[148:151], v[168:171], v[80:95]
  ds_read_b128 v[104:107], v15 offset:544
  s_waitcnt lgkmcnt(14)
  v_mfma_f32_32x32x16_bf16 v[64:79], v[136:139], v[172:175], v[64:79]
  ds_read_b128 v[184:187], v16 offset:640
  v_mfma_f32_32x32x16_bf16 v[80:95], v[144:147], v[172:175], v[80:95]
  ds_read_b128 v[188:191], v16 offset:672
  s_waitcnt lgkmcnt(6)
  v_mfma_f32_32x32x16_bf16 v[64:79], v[100:103], v[176:179], v[64:79]
  ds_read_b128 v[160:163], v16 offset:432
  s_waitcnt lgkmcnt(6)
  v_mfma_f32_32x32x16_bf16 v[80:95], v[108:111], v[176:179], v[80:95]
  ds_read_b128 v[116:119], v15 offset:448
  s_waitcnt lgkmcnt(5)
  v_mfma_f32_32x32x16_bf16 v[64:79], v[96:99], v[180:183], v[64:79]
  ds_read_b128 v[124:127], v15 offset:384
  s_waitcnt lgkmcnt(5)
  v_mfma_f32_32x32x16_bf16 v[80:95], v[104:107], v[180:183], v[80:95]
  ds_read_b128 v[164:167], v16 offset:464
  s_waitcnt lgkmcnt(5)
  v_mfma_f32_32x32x16_bf16 v[64:79], v[156:159], v[184:187], v[64:79]
  ds_read_b128 v[112:115], v15 offset:480
  v_mfma_f32_32x32x16_bf16 v[80:95], v[100:103], v[184:187], v[80:95]
  ds_read_b128 v[120:123], v15 offset:416
  s_waitcnt lgkmcnt(6)
  v_mfma_f32_32x32x16_bf16 v[64:79], v[152:155], v[188:191], v[64:79]
  ds_read_b128 v[168:171], v16 offset:496
  v_mfma_f32_32x32x16_bf16 v[80:95], v[96:99], v[188:191], v[80:95]
  ds_read_b128 v[172:175], v16 offset:528
  s_barrier
  s_waitcnt lgkmcnt(6)
  v_mfma_f32_32x32x16_bf16 v[64:79], v[116:119], v[160:163], v[64:79]
  ds_read_b128 v[176:179], v16 offset:288
  s_waitcnt lgkmcnt(6)
  v_mfma_f32_32x32x16_bf16 v[80:95], v[124:127], v[160:163], v[80:95]
  ds_read_b128 v[132:135], v15 offset:320
  s_waitcnt lgkmcnt(5)
  v_mfma_f32_32x32x16_bf16 v[64:79], v[112:115], v[164:167], v[64:79]
  ds_read_b128 v[140:143], v15 offset:256
  s_waitcnt lgkmcnt(5)
  v_mfma_f32_32x32x16_bf16 v[80:95], v[120:123], v[164:167], v[80:95]
  ds_read_b128 v[180:183], v16 offset:320
  s_waitcnt lgkmcnt(5)
  v_mfma_f32_32x32x16_bf16 v[64:79], v[108:111], v[168:171], v[64:79]
  ds_read_b128 v[128:131], v15 offset:352
  v_mfma_f32_32x32x16_bf16 v[80:95], v[116:119], v[168:171], v[80:95]
  ds_read_b128 v[136:139], v15 offset:288
  s_waitcnt lgkmcnt(6)
  v_mfma_f32_32x32x16_bf16 v[64:79], v[104:107], v[172:175], v[64:79]
  ds_read_b128 v[184:187], v16 offset:352
  v_mfma_f32_32x32x16_bf16 v[80:95], v[112:115], v[172:175], v[80:95]
  ds_read_b128 v[188:191], v16 offset:384
  s_waitcnt lgkmcnt(6)
  v_mfma_f32_32x32x16_bf16 v[64:79], v[132:135], v[176:179], v[64:79]
  ds_read_b128 v[160:163], v16 offset:144
  s_waitcnt lgkmcnt(6)
  v_mfma_f32_32x32x16_bf16 v[80:95], v[140:143], v[176:179], v[80:95]
  ds_read_b128 v[148:151], v15 offset:192
  s_waitcnt lgkmcnt(5)
  v_mfma_f32_32x32x16_bf16 v[64:79], v[128:131], v[180:183], v[64:79]
  ds_read_b128 v[156:159], v15 offset:128
  s_waitcnt lgkmcnt(5)
  v_mfma_f32_32x32x16_bf16 v[80:95], v[136:139], v[180:183], v[80:95]
  ds_read_b128 v[164:167], v16 offset:176
  s_waitcnt lgkmcnt(5)
  v_mfma_f32_32x32x16_bf16 v[64:79], v[124:127], v[184:187], v[64:79]
  ds_read_b128 v[144:147], v15 offset:224
  v_mfma_f32_32x32x16_bf16 v[80:95], v[132:135], v[184:187], v[80:95]
  ds_read_b128 v[152:155], v15 offset:160
  s_waitcnt lgkmcnt(6)
  v_mfma_f32_32x32x16_bf16 v[64:79], v[120:123], v[188:191], v[64:79]
  ds_read_b128 v[168:171], v16 offset:208
  v_mfma_f32_32x32x16_bf16 v[80:95], v[128:131], v[188:191], v[80:95]
  ds_read_b128 v[172:175], v16 offset:240
  s_waitcnt lgkmcnt(6)
  v_mfma_f32_32x32x16_bf16 v[64:79], v[148:151], v[160:163], v[64:79]
  ds_read_b128 v[176:179], v16 offset:0
  s_waitcnt lgkmcnt(6)
  v_mfma_f32_32x32x16_bf16 v[80:95], v[156:159], v[160:163], v[80:95]
  ds_read_b128 v[100:103], v15 offset:64
  s_waitcnt lgkmcnt(5)
  v_mfma_f32_32x32x16_bf16 v[64:79], v[144:147], v[164:167], v[64:79]
  ds_read_b128 v[108:111], v15 offset:0
  s_waitcnt lgkmcnt(5)
  v_mfma_f32_32x32x16_bf16 v[80:95], v[152:155], v[164:167], v[80:95]
  ds_read_b128 v[180:183], v16 offset:32
  s_waitcnt lgkmcnt(5)
  v_mfma_f32_32x32x16_bf16 v[64:79], v[140:143], v[168:171], v[64:79]
  ds_read_b128 v[96:99], v15 offset:96
  v_mfma_f32_32x32x16_bf16 v[80:95], v[148:151], v[168:171], v[80:95]
  ds_read_b128 v[104:107], v15 offset:32
  s_waitcnt lgkmcnt(6)
  v_mfma_f32_32x32x16_bf16 v[64:79], v[136:139], v[172:175], v[64:79]
  ds_read_b128 v[184:187], v16 offset:64
  v_mfma_f32_32x32x16_bf16 v[80:95], v[144:147], v[172:175], v[80:95]
  ds_read_b128 v[188:191], v16 offset:96
  s_waitcnt lgkmcnt(6)
  v_mfma_f32_32x32x16_bf16 v[64:79], v[100:103], v[176:179], v[64:79]
  ds_read_b128 v[160:163], v6 offset:1008
  ds_read_b128 v[124:127], v5 offset:960
  s_waitcnt lgkmcnt(7)
  v_mfma_f32_32x32x16_bf16 v[80:95], v[108:111], v[176:179], v[80:95]
  ds_read_b128 v[132:135], v5 offset:896
  s_waitcnt lgkmcnt(6)
  v_mfma_f32_32x32x16_bf16 v[64:79], v[96:99], v[180:183], v[64:79]
  ds_read_b128 v[164:167], v6 offset:1040
  s_waitcnt lgkmcnt(6)
  v_mfma_f32_32x32x16_bf16 v[80:95], v[104:107], v[180:183], v[80:95]
  ds_read_b128 v[120:123], v5 offset:992
  s_waitcnt lgkmcnt(6)
  v_mfma_f32_32x32x16_bf16 v[64:79], v[156:159], v[184:187], v[64:79]
  ds_read_b128 v[128:131], v5 offset:928
  ds_read_b128 v[168:171], v6 offset:1072
  v_mfma_f32_32x32x16_bf16 v[80:95], v[100:103], v[184:187], v[80:95]
  ds_read_b128 v[116:119], v5 offset:1024
  s_waitcnt lgkmcnt(8)
  v_mfma_f32_32x32x16_bf16 v[64:79], v[152:155], v[188:191], v[64:79]
  ds_read_b128 v[172:175], v6 offset:1104
  v_mfma_f32_32x32x16_bf16 v[80:95], v[96:99], v[188:191], v[80:95]
  ds_read_b128 v[112:115], v5 offset:1056
  s_barrier
  s_waitcnt lgkmcnt(8)
  v_mfma_f32_32x32x16_bf16 v[32:47], v[124:127], v[160:163], 0
  ds_read_b128 v[176:179], v6 offset:864
  s_waitcnt lgkmcnt(8)
  v_mfma_f32_32x32x16_bf16 v[48:63], v[132:135], v[160:163], 0
  ds_read_b128 v[140:143], v5 offset:832
  s_waitcnt lgkmcnt(7)
  v_mfma_f32_32x32x16_bf16 v[32:47], v[120:123], v[164:167], v[32:47]
  ds_read_b128 v[148:151], v5 offset:768
  s_waitcnt lgkmcnt(7)
  v_mfma_f32_32x32x16_bf16 v[48:63], v[128:131], v[164:167], v[48:63]
  ds_read_b128 v[180:183], v6 offset:896
  s_waitcnt lgkmcnt(6)
  v_mfma_f32_32x32x16_bf16 v[32:47], v[116:119], v[168:171], v[32:47]
  ds_read_b128 v[136:139], v5 offset:864
  v_mfma_f32_32x32x16_bf16 v[48:63], v[124:127], v[168:171], v[48:63]
  ds_read_b128 v[144:147], v5 offset:800
  s_waitcnt lgkmcnt(6)
  v_mfma_f32_32x32x16_bf16 v[32:47], v[112:115], v[172:175], v[32:47]
  ds_read_b128 v[184:187], v6 offset:928
  v_mfma_f32_32x32x16_bf16 v[48:63], v[120:123], v[172:175], v[48:63]
  ds_read_b128 v[188:191], v6 offset:960
  s_waitcnt lgkmcnt(6)
  v_mfma_f32_32x32x16_bf16 v[32:47], v[140:143], v[176:179], v[32:47]
  ds_read_b128 v[160:163], v6 offset:720
  ds_read_b128 v[156:159], v5 offset:704
  s_waitcnt lgkmcnt(7)
  v_mfma_f32_32x32x16_bf16 v[48:63], v[148:151], v[176:179], v[48:63]
  ds_read_b128 v[100:103], v5 offset:640
  ds_read_b128 v[164:167], v6 offset:752
  s_waitcnt lgkmcnt(7)
  v_mfma_f32_32x32x16_bf16 v[32:47], v[136:139], v[180:183], v[32:47]
  ds_read_b128 v[152:155], v5 offset:736
  ds_read_b128 v[96:99], v5 offset:672
  s_waitcnt lgkmcnt(8)
  v_mfma_f32_32x32x16_bf16 v[48:63], v[144:147], v[180:183], v[48:63]
  ds_read_b128 v[168:171], v6 offset:784
  ds_read_b128 v[172:175], v6 offset:816
  s_waitcnt lgkmcnt(9)
  v_mfma_f32_32x32x16_bf16 v[32:47], v[132:135], v[184:187], v[32:47]
  ds_write_b128 v10, v[64:67] offset:0
  ds_write_b128 v10, v[68:71] offset:1024
  v_mfma_f32_32x32x16_bf16 v[48:63], v[140:143], v[184:187], v[48:63]
  ds_write_b128 v10, v[72:75] offset:8192
  ds_write_b128 v10, v[76:79] offset:9216
  s_waitcnt lgkmcnt(12)
  v_mfma_f32_32x32x16_bf16 v[32:47], v[128:131], v[188:191], v[32:47]
  ds_write_b128 v10, v[80:83] offset:16384
  ds_write_b128 v10, v[84:87] offset:17408
  v_mfma_f32_32x32x16_bf16 v[48:63], v[136:139], v[188:191], v[48:63]
  ds_write_b128 v10, v[88:91] offset:24576
  ds_write_b128 v10, v[92:95] offset:25600
  s_waitcnt lgkmcnt(14)
  v_mfma_f32_32x32x16_bf16 v[32:47], v[156:159], v[160:163], v[32:47]
  ds_read_b128 v[176:179], v6 offset:576
  s_waitcnt lgkmcnt(14)
  v_mfma_f32_32x32x16_bf16 v[48:63], v[100:103], v[160:163], v[48:63]
  ds_read_b128 v[108:111], v5 offset:576
  s_waitcnt lgkmcnt(13)
  v_mfma_f32_32x32x16_bf16 v[32:47], v[152:155], v[164:167], v[32:47]
  ds_read_b128 v[116:119], v5 offset:512
  s_waitcnt lgkmcnt(13)
  v_mfma_f32_32x32x16_bf16 v[48:63], v[96:99], v[164:167], v[48:63]
  ds_read_b128 v[180:183], v6 offset:608
  s_waitcnt lgkmcnt(13)
  v_mfma_f32_32x32x16_bf16 v[32:47], v[148:151], v[168:171], v[32:47]
  ds_read_b128 v[104:107], v5 offset:608
  v_mfma_f32_32x32x16_bf16 v[48:63], v[156:159], v[168:171], v[48:63]
  ds_read_b128 v[112:115], v5 offset:544
  s_waitcnt lgkmcnt(14)
  v_mfma_f32_32x32x16_bf16 v[32:47], v[144:147], v[172:175], v[32:47]
  ds_read_b128 v[184:187], v6 offset:640
  v_mfma_f32_32x32x16_bf16 v[48:63], v[152:155], v[172:175], v[48:63]
  ds_read_b128 v[188:191], v6 offset:672
  s_waitcnt lgkmcnt(6)
  v_mfma_f32_32x32x16_bf16 v[32:47], v[108:111], v[176:179], v[32:47]
  ds_read_b128 v[160:163], v6 offset:432
  s_waitcnt lgkmcnt(6)
  v_mfma_f32_32x32x16_bf16 v[48:63], v[116:119], v[176:179], v[48:63]
  ds_read_b128 v[124:127], v5 offset:448
  s_waitcnt lgkmcnt(5)
  v_mfma_f32_32x32x16_bf16 v[32:47], v[104:107], v[180:183], v[32:47]
  ds_read_b128 v[132:135], v5 offset:384
  s_waitcnt lgkmcnt(5)
  v_mfma_f32_32x32x16_bf16 v[48:63], v[112:115], v[180:183], v[48:63]
  ds_read_b128 v[164:167], v6 offset:464
  s_waitcnt lgkmcnt(5)
  v_mfma_f32_32x32x16_bf16 v[32:47], v[100:103], v[184:187], v[32:47]
  ds_read_b128 v[120:123], v5 offset:480
  v_mfma_f32_32x32x16_bf16 v[48:63], v[108:111], v[184:187], v[48:63]
  ds_read_b128 v[128:131], v5 offset:416
  s_waitcnt lgkmcnt(6)
  v_mfma_f32_32x32x16_bf16 v[32:47], v[96:99], v[188:191], v[32:47]
  ds_read_b128 v[168:171], v6 offset:496
  v_mfma_f32_32x32x16_bf16 v[48:63], v[104:107], v[188:191], v[48:63]
  ds_read_b128 v[172:175], v6 offset:528
  s_barrier
  s_waitcnt lgkmcnt(6)
  v_mfma_f32_32x32x16_bf16 v[32:47], v[124:127], v[160:163], v[32:47]
  ds_read_b128 v[176:179], v6 offset:288
  s_waitcnt lgkmcnt(6)
  v_mfma_f32_32x32x16_bf16 v[48:63], v[132:135], v[160:163], v[48:63]
  ds_read_b128 v[140:143], v5 offset:320
  s_waitcnt lgkmcnt(5)
  v_mfma_f32_32x32x16_bf16 v[32:47], v[120:123], v[164:167], v[32:47]
  ds_read_b128 v[148:151], v5 offset:256
  s_waitcnt lgkmcnt(5)
  v_mfma_f32_32x32x16_bf16 v[48:63], v[128:131], v[164:167], v[48:63]
  ds_read_b128 v[180:183], v6 offset:320
  s_waitcnt lgkmcnt(5)
  v_mfma_f32_32x32x16_bf16 v[32:47], v[116:119], v[168:171], v[32:47]
  ds_read_b128 v[136:139], v5 offset:352
  v_mfma_f32_32x32x16_bf16 v[48:63], v[124:127], v[168:171], v[48:63]
  ds_read_b128 v[144:147], v5 offset:288
  s_waitcnt lgkmcnt(6)
  v_mfma_f32_32x32x16_bf16 v[32:47], v[112:115], v[172:175], v[32:47]
  ds_read_b128 v[184:187], v6 offset:352
  v_mfma_f32_32x32x16_bf16 v[48:63], v[120:123], v[172:175], v[48:63]
  ds_read_b128 v[188:191], v6 offset:384
  s_waitcnt lgkmcnt(6)
  v_mfma_f32_32x32x16_bf16 v[32:47], v[140:143], v[176:179], v[32:47]
  ds_read_b128 v[160:163], v6 offset:144
  s_waitcnt lgkmcnt(6)
  v_mfma_f32_32x32x16_bf16 v[48:63], v[148:151], v[176:179], v[48:63]
  ds_read_b128 v[156:159], v5 offset:192
  s_waitcnt lgkmcnt(5)
  v_mfma_f32_32x32x16_bf16 v[32:47], v[136:139], v[180:183], v[32:47]
  ds_read_b128 v[100:103], v5 offset:128
  s_waitcnt lgkmcnt(5)
  v_mfma_f32_32x32x16_bf16 v[48:63], v[144:147], v[180:183], v[48:63]
  ds_read_b128 v[164:167], v6 offset:176
  s_waitcnt lgkmcnt(5)
  v_mfma_f32_32x32x16_bf16 v[32:47], v[132:135], v[184:187], v[32:47]
  ds_read_b128 v[152:155], v5 offset:224
  v_mfma_f32_32x32x16_bf16 v[48:63], v[140:143], v[184:187], v[48:63]
  ds_read_b128 v[96:99], v5 offset:160
  s_waitcnt lgkmcnt(6)
  v_mfma_f32_32x32x16_bf16 v[32:47], v[128:131], v[188:191], v[32:47]
  ds_read_b128 v[168:171], v6 offset:208
  v_mfma_f32_32x32x16_bf16 v[48:63], v[136:139], v[188:191], v[48:63]
  ds_read_b128 v[172:175], v6 offset:240
  s_waitcnt lgkmcnt(6)
  v_mfma_f32_32x32x16_bf16 v[32:47], v[156:159], v[160:163], v[32:47]
  ds_read_b128 v[176:179], v6 offset:0
  s_waitcnt lgkmcnt(6)
  v_mfma_f32_32x32x16_bf16 v[48:63], v[100:103], v[160:163], v[48:63]
  ds_read_b128 v[108:111], v5 offset:64
  s_waitcnt lgkmcnt(5)
  v_mfma_f32_32x32x16_bf16 v[32:47], v[152:155], v[164:167], v[32:47]
  ds_read_b128 v[116:119], v5 offset:0
  s_waitcnt lgkmcnt(5)
  v_mfma_f32_32x32x16_bf16 v[48:63], v[96:99], v[164:167], v[48:63]
  ds_read_b128 v[180:183], v6 offset:32
  s_waitcnt lgkmcnt(5)
  v_mfma_f32_32x32x16_bf16 v[32:47], v[148:151], v[168:171], v[32:47]
  ds_read_b128 v[104:107], v5 offset:96
  v_mfma_f32_32x32x16_bf16 v[48:63], v[156:159], v[168:171], v[48:63]
  ds_read_b128 v[112:115], v5 offset:32
  s_waitcnt lgkmcnt(6)
  v_mfma_f32_32x32x16_bf16 v[32:47], v[144:147], v[172:175], v[32:47]
  ds_read_b128 v[184:187], v6 offset:64
  v_mfma_f32_32x32x16_bf16 v[48:63], v[152:155], v[172:175], v[48:63]
  ds_read_b128 v[188:191], v6 offset:96
  s_waitcnt lgkmcnt(6)
  v_mfma_f32_32x32x16_bf16 v[32:47], v[108:111], v[176:179], v[32:47]
  ds_read_b128 v[160:163], v16 offset:1008
  ds_read_b128 v[132:135], v15 offset:960
  s_waitcnt lgkmcnt(7)
  v_mfma_f32_32x32x16_bf16 v[48:63], v[116:119], v[176:179], v[48:63]
  ds_read_b128 v[140:143], v15 offset:896
  s_waitcnt lgkmcnt(6)
  v_mfma_f32_32x32x16_bf16 v[32:47], v[104:107], v[180:183], v[32:47]
  ds_read_b128 v[164:167], v16 offset:1040
  s_waitcnt lgkmcnt(6)
  v_mfma_f32_32x32x16_bf16 v[48:63], v[112:115], v[180:183], v[48:63]
  ds_read_b128 v[128:131], v15 offset:992
  s_waitcnt lgkmcnt(6)
  v_mfma_f32_32x32x16_bf16 v[32:47], v[100:103], v[184:187], v[32:47]
  ds_read_b128 v[136:139], v15 offset:928
  ds_read_b128 v[168:171], v16 offset:1072
  v_mfma_f32_32x32x16_bf16 v[48:63], v[108:111], v[184:187], v[48:63]
  ds_read_b128 v[124:127], v15 offset:1024
  s_waitcnt lgkmcnt(8)
  v_mfma_f32_32x32x16_bf16 v[32:47], v[96:99], v[188:191], v[32:47]
  ds_read_b128 v[172:175], v16 offset:1104
  v_mfma_f32_32x32x16_bf16 v[48:63], v[104:107], v[188:191], v[48:63]
  ds_read_b128 v[120:123], v15 offset:1056
  s_barrier
  s_waitcnt lgkmcnt(8)
  v_mfma_f32_32x32x16_bf16 v[64:79], v[132:135], v[160:163], 0
  ds_read_b128 v[176:179], v16 offset:864
  s_waitcnt lgkmcnt(8)
  v_mfma_f32_32x32x16_bf16 v[80:95], v[140:143], v[160:163], 0
  ds_read_b128 v[148:151], v15 offset:832
  s_waitcnt lgkmcnt(7)
  v_mfma_f32_32x32x16_bf16 v[64:79], v[128:131], v[164:167], v[64:79]
  ds_read_b128 v[156:159], v15 offset:768
  s_waitcnt lgkmcnt(7)
  v_mfma_f32_32x32x16_bf16 v[80:95], v[136:139], v[164:167], v[80:95]
  ds_read_b128 v[180:183], v16 offset:896
  s_waitcnt lgkmcnt(6)
  v_mfma_f32_32x32x16_bf16 v[64:79], v[124:127], v[168:171], v[64:79]
  ds_read_b128 v[144:147], v15 offset:864
  v_mfma_f32_32x32x16_bf16 v[80:95], v[132:135], v[168:171], v[80:95]
  ds_read_b128 v[152:155], v15 offset:800
  s_waitcnt lgkmcnt(6)
  v_mfma_f32_32x32x16_bf16 v[64:79], v[120:123], v[172:175], v[64:79]
  ds_read_b128 v[184:187], v16 offset:928
  v_mfma_f32_32x32x16_bf16 v[80:95], v[128:131], v[172:175], v[80:95]
  ds_read_b128 v[188:191], v16 offset:960
  s_waitcnt lgkmcnt(6)
  v_mfma_f32_32x32x16_bf16 v[64:79], v[148:151], v[176:179], v[64:79]
  ds_read_b128 v[160:163], v16 offset:720
  ds_read_b128 v[100:103], v15 offset:704
  s_waitcnt lgkmcnt(7)
  v_mfma_f32_32x32x16_bf16 v[80:95], v[156:159], v[176:179], v[80:95]
  ds_read_b128 v[108:111], v15 offset:640
  ds_read_b128 v[164:167], v16 offset:752
  s_waitcnt lgkmcnt(7)
  v_mfma_f32_32x32x16_bf16 v[64:79], v[144:147], v[180:183], v[64:79]
  ds_read_b128 v[96:99], v15 offset:736
  ds_read_b128 v[104:107], v15 offset:672
  s_waitcnt lgkmcnt(8)
  v_mfma_f32_32x32x16_bf16 v[80:95], v[152:155], v[180:183], v[80:95]
  ds_read_b128 v[168:171], v16 offset:784
  ds_read_b128 v[172:175], v16 offset:816
  s_waitcnt lgkmcnt(9)
  v_mfma_f32_32x32x16_bf16 v[64:79], v[140:143], v[184:187], v[64:79]
  ds_write_b128 v10, v[32:35] offset:0
  ds_write_b128 v10, v[36:39] offset:1024
  v_mfma_f32_32x32x16_bf16 v[80:95], v[148:151], v[184:187], v[80:95]
  ds_write_b128 v10, v[40:43] offset:8192
  ds_write_b128 v10, v[44:47] offset:9216
  s_waitcnt lgkmcnt(12)
  v_mfma_f32_32x32x16_bf16 v[64:79], v[136:139], v[188:191], v[64:79]
  ds_write_b128 v10, v[48:51] offset:16384
  ds_write_b128 v10, v[52:55] offset:17408
  v_mfma_f32_32x32x16_bf16 v[80:95], v[144:147], v[188:191], v[80:95]
  ds_write_b128 v10, v[56:59] offset:24576
  ds_write_b128 v10, v[60:63] offset:25600
  s_waitcnt lgkmcnt(14)
  v_mfma_f32_32x32x16_bf16 v[64:79], v[100:103], v[160:163], v[64:79]
  ds_read_b128 v[176:179], v16 offset:576
  s_waitcnt lgkmcnt(14)
  v_mfma_f32_32x32x16_bf16 v[80:95], v[108:111], v[160:163], v[80:95]
  ds_read_b128 v[116:119], v15 offset:576
  s_waitcnt lgkmcnt(13)
  v_mfma_f32_32x32x16_bf16 v[64:79], v[96:99], v[164:167], v[64:79]
  ds_read_b128 v[124:127], v15 offset:512
  s_waitcnt lgkmcnt(13)
  v_mfma_f32_32x32x16_bf16 v[80:95], v[104:107], v[164:167], v[80:95]
  ds_read_b128 v[180:183], v16 offset:608
  s_waitcnt lgkmcnt(13)
  v_mfma_f32_32x32x16_bf16 v[64:79], v[156:159], v[168:171], v[64:79]
  ds_read_b128 v[112:115], v15 offset:608
  v_mfma_f32_32x32x16_bf16 v[80:95], v[100:103], v[168:171], v[80:95]
  ds_read_b128 v[120:123], v15 offset:544
  s_waitcnt lgkmcnt(14)
  v_mfma_f32_32x32x16_bf16 v[64:79], v[152:155], v[172:175], v[64:79]
  ds_read_b128 v[184:187], v16 offset:640
  v_mfma_f32_32x32x16_bf16 v[80:95], v[96:99], v[172:175], v[80:95]
  ds_read_b128 v[188:191], v16 offset:672
  s_waitcnt lgkmcnt(6)
  v_mfma_f32_32x32x16_bf16 v[64:79], v[116:119], v[176:179], v[64:79]
  ds_read_b128 v[160:163], v16 offset:432
  s_waitcnt lgkmcnt(6)
  v_mfma_f32_32x32x16_bf16 v[80:95], v[124:127], v[176:179], v[80:95]
  ds_read_b128 v[132:135], v15 offset:448
  s_waitcnt lgkmcnt(5)
  v_mfma_f32_32x32x16_bf16 v[64:79], v[112:115], v[180:183], v[64:79]
  ds_read_b128 v[140:143], v15 offset:384
  s_waitcnt lgkmcnt(5)
  v_mfma_f32_32x32x16_bf16 v[80:95], v[120:123], v[180:183], v[80:95]
  ds_read_b128 v[164:167], v16 offset:464
  s_waitcnt lgkmcnt(5)
  v_mfma_f32_32x32x16_bf16 v[64:79], v[108:111], v[184:187], v[64:79]
  ds_read_b128 v[128:131], v15 offset:480
  v_mfma_f32_32x32x16_bf16 v[80:95], v[116:119], v[184:187], v[80:95]
  ds_read_b128 v[136:139], v15 offset:416
  s_waitcnt lgkmcnt(6)
  v_mfma_f32_32x32x16_bf16 v[64:79], v[104:107], v[188:191], v[64:79]
  ds_read_b128 v[168:171], v16 offset:496
  v_mfma_f32_32x32x16_bf16 v[80:95], v[112:115], v[188:191], v[80:95]
  ds_read_b128 v[172:175], v16 offset:528
  s_barrier
  s_waitcnt lgkmcnt(6)
  v_mfma_f32_32x32x16_bf16 v[64:79], v[132:135], v[160:163], v[64:79]
  ds_read_b128 v[176:179], v16 offset:288
  s_waitcnt lgkmcnt(6)
  v_mfma_f32_32x32x16_bf16 v[80:95], v[140:143], v[160:163], v[80:95]
  ds_read_b128 v[148:151], v15 offset:320
  s_waitcnt lgkmcnt(5)
  v_mfma_f32_32x32x16_bf16 v[64:79], v[128:131], v[164:167], v[64:79]
  ds_read_b128 v[156:159], v15 offset:256
  s_waitcnt lgkmcnt(5)
  v_mfma_f32_32x32x16_bf16 v[80:95], v[136:139], v[164:167], v[80:95]
  ds_read_b128 v[180:183], v16 offset:320
  s_waitcnt lgkmcnt(5)
  v_mfma_f32_32x32x16_bf16 v[64:79], v[124:127], v[168:171], v[64:79]
  ds_read_b128 v[144:147], v15 offset:352
  v_mfma_f32_32x32x16_bf16 v[80:95], v[132:135], v[168:171], v[80:95]
  ds_read_b128 v[152:155], v15 offset:288
  s_waitcnt lgkmcnt(6)
  v_mfma_f32_32x32x16_bf16 v[64:79], v[120:123], v[172:175], v[64:79]
  ds_read_b128 v[184:187], v16 offset:352
  v_mfma_f32_32x32x16_bf16 v[80:95], v[128:131], v[172:175], v[80:95]
  ds_read_b128 v[188:191], v16 offset:384
  s_waitcnt lgkmcnt(6)
  v_mfma_f32_32x32x16_bf16 v[64:79], v[148:151], v[176:179], v[64:79]
  ds_read_b128 v[160:163], v16 offset:144
  s_waitcnt lgkmcnt(6)
  v_mfma_f32_32x32x16_bf16 v[80:95], v[156:159], v[176:179], v[80:95]
  ds_read_b128 v[100:103], v15 offset:192
  s_waitcnt lgkmcnt(5)
  v_mfma_f32_32x32x16_bf16 v[64:79], v[144:147], v[180:183], v[64:79]
  ds_read_b128 v[108:111], v15 offset:128
  s_waitcnt lgkmcnt(5)
  v_mfma_f32_32x32x16_bf16 v[80:95], v[152:155], v[180:183], v[80:95]
  ds_read_b128 v[164:167], v16 offset:176
  s_waitcnt lgkmcnt(5)
  v_mfma_f32_32x32x16_bf16 v[64:79], v[140:143], v[184:187], v[64:79]
  ds_read_b128 v[96:99], v15 offset:224
  v_mfma_f32_32x32x16_bf16 v[80:95], v[148:151], v[184:187], v[80:95]
  ds_read_b128 v[104:107], v15 offset:160
  s_waitcnt lgkmcnt(6)
  v_mfma_f32_32x32x16_bf16 v[64:79], v[136:139], v[188:191], v[64:79]
  ds_read_b128 v[168:171], v16 offset:208
  v_mfma_f32_32x32x16_bf16 v[80:95], v[144:147], v[188:191], v[80:95]
  ds_read_b128 v[172:175], v16 offset:240
  s_waitcnt lgkmcnt(6)
  v_mfma_f32_32x32x16_bf16 v[64:79], v[100:103], v[160:163], v[64:79]
  ds_read_b128 v[176:179], v16 offset:0
  s_waitcnt lgkmcnt(6)
  v_mfma_f32_32x32x16_bf16 v[80:95], v[108:111], v[160:163], v[80:95]
  ds_read_b128 v[116:119], v15 offset:64
  s_waitcnt lgkmcnt(5)
  v_mfma_f32_32x32x16_bf16 v[64:79], v[96:99], v[164:167], v[64:79]
  ds_read_b128 v[124:127], v15 offset:0
  s_waitcnt lgkmcnt(5)
  v_mfma_f32_32x32x16_bf16 v[80:95], v[104:107], v[164:167], v[80:95]
  ds_read_b128 v[180:183], v16 offset:32
  s_waitcnt lgkmcnt(5)
  v_mfma_f32_32x32x16_bf16 v[64:79], v[156:159], v[168:171], v[64:79]
  ds_read_b128 v[112:115], v15 offset:96
  v_mfma_f32_32x32x16_bf16 v[80:95], v[100:103], v[168:171], v[80:95]
  ds_read_b128 v[120:123], v15 offset:32
  s_waitcnt lgkmcnt(6)
  v_mfma_f32_32x32x16_bf16 v[64:79], v[152:155], v[172:175], v[64:79]
  ds_read_b128 v[184:187], v16 offset:64
  v_mfma_f32_32x32x16_bf16 v[80:95], v[96:99], v[172:175], v[80:95]
  ds_read_b128 v[188:191], v16 offset:96
  s_waitcnt lgkmcnt(6)
  v_mfma_f32_32x32x16_bf16 v[64:79], v[116:119], v[176:179], v[64:79]
  ds_read_b128 v[160:163], v6 offset:1008
  ds_read_b128 v[140:143], v5 offset:960
  s_waitcnt lgkmcnt(7)
  v_mfma_f32_32x32x16_bf16 v[80:95], v[124:127], v[176:179], v[80:95]
  ds_read_b128 v[148:151], v5 offset:896
  s_waitcnt lgkmcnt(6)
  v_mfma_f32_32x32x16_bf16 v[64:79], v[112:115], v[180:183], v[64:79]
  ds_read_b128 v[164:167], v6 offset:1040
  s_waitcnt lgkmcnt(6)
  v_mfma_f32_32x32x16_bf16 v[80:95], v[120:123], v[180:183], v[80:95]
  ds_read_b128 v[136:139], v5 offset:992
  s_waitcnt lgkmcnt(6)
  v_mfma_f32_32x32x16_bf16 v[64:79], v[108:111], v[184:187], v[64:79]
  ds_read_b128 v[144:147], v5 offset:928
  ds_read_b128 v[168:171], v6 offset:1072
  v_mfma_f32_32x32x16_bf16 v[80:95], v[116:119], v[184:187], v[80:95]
  ds_read_b128 v[132:135], v5 offset:1024
  s_waitcnt lgkmcnt(8)
  v_mfma_f32_32x32x16_bf16 v[64:79], v[104:107], v[188:191], v[64:79]
  ds_read_b128 v[172:175], v6 offset:1104
  v_mfma_f32_32x32x16_bf16 v[80:95], v[112:115], v[188:191], v[80:95]
  ds_read_b128 v[128:131], v5 offset:1056
  s_barrier
  s_waitcnt lgkmcnt(8)
  v_mfma_f32_32x32x16_bf16 v[32:47], v[140:143], v[160:163], 0
  ds_read_b128 v[176:179], v6 offset:864
  s_waitcnt lgkmcnt(8)
  v_mfma_f32_32x32x16_bf16 v[48:63], v[148:151], v[160:163], 0
  ds_read_b128 v[156:159], v5 offset:832
  s_waitcnt lgkmcnt(7)
  v_mfma_f32_32x32x16_bf16 v[32:47], v[136:139], v[164:167], v[32:47]
  ds_read_b128 v[100:103], v5 offset:768
  s_waitcnt lgkmcnt(7)
  v_mfma_f32_32x32x16_bf16 v[48:63], v[144:147], v[164:167], v[48:63]
  ds_read_b128 v[180:183], v6 offset:896
  s_waitcnt lgkmcnt(6)
  v_mfma_f32_32x32x16_bf16 v[32:47], v[132:135], v[168:171], v[32:47]
  ds_read_b128 v[152:155], v5 offset:864
  v_mfma_f32_32x32x16_bf16 v[48:63], v[140:143], v[168:171], v[48:63]
  ds_read_b128 v[96:99], v5 offset:800
  s_waitcnt lgkmcnt(6)
  v_mfma_f32_32x32x16_bf16 v[32:47], v[128:131], v[172:175], v[32:47]
  ds_read_b128 v[184:187], v6 offset:928
  v_mfma_f32_32x32x16_bf16 v[48:63], v[136:139], v[172:175], v[48:63]
  ds_read_b128 v[188:191], v6 offset:960
  s_waitcnt lgkmcnt(6)
  v_mfma_f32_32x32x16_bf16 v[32:47], v[156:159], v[176:179], v[32:47]
  ds_read_b128 v[160:163], v6 offset:720
  ds_read_b128 v[108:111], v5 offset:704
  s_waitcnt lgkmcnt(7)
  v_mfma_f32_32x32x16_bf16 v[48:63], v[100:103], v[176:179], v[48:63]
  ds_read_b128 v[116:119], v5 offset:640
  ds_read_b128 v[164:167], v6 offset:752
  s_waitcnt lgkmcnt(7)
  v_mfma_f32_32x32x16_bf16 v[32:47], v[152:155], v[180:183], v[32:47]
  ds_read_b128 v[104:107], v5 offset:736
  ds_read_b128 v[112:115], v5 offset:672
  s_waitcnt lgkmcnt(8)
  v_mfma_f32_32x32x16_bf16 v[48:63], v[96:99], v[180:183], v[48:63]
  ds_read_b128 v[168:171], v6 offset:784
  ds_read_b128 v[172:175], v6 offset:816
  s_waitcnt lgkmcnt(9)
  v_mfma_f32_32x32x16_bf16 v[32:47], v[148:151], v[184:187], v[32:47]
  ds_write_b128 v10, v[64:67] offset:0
  ds_write_b128 v10, v[68:71] offset:1024
  v_mfma_f32_32x32x16_bf16 v[48:63], v[156:159], v[184:187], v[48:63]
  ds_write_b128 v10, v[72:75] offset:8192
  ds_write_b128 v10, v[76:79] offset:9216
  s_waitcnt lgkmcnt(12)
  v_mfma_f32_32x32x16_bf16 v[32:47], v[144:147], v[188:191], v[32:47]
  ds_write_b128 v10, v[80:83] offset:16384
  ds_write_b128 v10, v[84:87] offset:17408
  v_mfma_f32_32x32x16_bf16 v[48:63], v[152:155], v[188:191], v[48:63]
  ds_write_b128 v10, v[88:91] offset:24576
  ds_write_b128 v10, v[92:95] offset:25600
  s_waitcnt lgkmcnt(14)
  v_mfma_f32_32x32x16_bf16 v[32:47], v[108:111], v[160:163], v[32:47]
  ds_read_b128 v[176:179], v6 offset:576
  s_waitcnt lgkmcnt(14)
  v_mfma_f32_32x32x16_bf16 v[48:63], v[116:119], v[160:163], v[48:63]
  ds_read_b128 v[124:127], v5 offset:576
  s_waitcnt lgkmcnt(13)
  v_mfma_f32_32x32x16_bf16 v[32:47], v[104:107], v[164:167], v[32:47]
  ds_read_b128 v[132:135], v5 offset:512
  s_waitcnt lgkmcnt(13)
  v_mfma_f32_32x32x16_bf16 v[48:63], v[112:115], v[164:167], v[48:63]
  ds_read_b128 v[180:183], v6 offset:608
  s_waitcnt lgkmcnt(13)
  v_mfma_f32_32x32x16_bf16 v[32:47], v[100:103], v[168:171], v[32:47]
  ds_read_b128 v[120:123], v5 offset:608
  v_mfma_f32_32x32x16_bf16 v[48:63], v[108:111], v[168:171], v[48:63]
  ds_read_b128 v[128:131], v5 offset:544
  s_waitcnt lgkmcnt(14)
  v_mfma_f32_32x32x16_bf16 v[32:47], v[96:99], v[172:175], v[32:47]
  ds_read_b128 v[184:187], v6 offset:640
  v_mfma_f32_32x32x16_bf16 v[48:63], v[104:107], v[172:175], v[48:63]
  ds_read_b128 v[188:191], v6 offset:672
  s_waitcnt lgkmcnt(6)
  v_mfma_f32_32x32x16_bf16 v[32:47], v[124:127], v[176:179], v[32:47]
  ds_read_b128 v[160:163], v6 offset:432
  s_waitcnt lgkmcnt(6)
  v_mfma_f32_32x32x16_bf16 v[48:63], v[132:135], v[176:179], v[48:63]
  ds_read_b128 v[140:143], v5 offset:448
  s_waitcnt lgkmcnt(5)
  v_mfma_f32_32x32x16_bf16 v[32:47], v[120:123], v[180:183], v[32:47]
  ds_read_b128 v[148:151], v5 offset:384
  s_waitcnt lgkmcnt(5)
  v_mfma_f32_32x32x16_bf16 v[48:63], v[128:131], v[180:183], v[48:63]
  ds_read_b128 v[164:167], v6 offset:464
  s_waitcnt lgkmcnt(5)
  v_mfma_f32_32x32x16_bf16 v[32:47], v[116:119], v[184:187], v[32:47]
  ds_read_b128 v[136:139], v5 offset:480
  v_mfma_f32_32x32x16_bf16 v[48:63], v[124:127], v[184:187], v[48:63]
  ds_read_b128 v[144:147], v5 offset:416
  s_waitcnt lgkmcnt(6)
  v_mfma_f32_32x32x16_bf16 v[32:47], v[112:115], v[188:191], v[32:47]
  ds_read_b128 v[168:171], v6 offset:496
  v_mfma_f32_32x32x16_bf16 v[48:63], v[120:123], v[188:191], v[48:63]
  ds_read_b128 v[172:175], v6 offset:528
  s_barrier
  s_waitcnt lgkmcnt(6)
  v_mfma_f32_32x32x16_bf16 v[32:47], v[140:143], v[160:163], v[32:47]
  ds_read_b128 v[176:179], v6 offset:288
  s_waitcnt lgkmcnt(6)
  v_mfma_f32_32x32x16_bf16 v[48:63], v[148:151], v[160:163], v[48:63]
  ds_read_b128 v[156:159], v5 offset:320
  s_waitcnt lgkmcnt(5)
  v_mfma_f32_32x32x16_bf16 v[32:47], v[136:139], v[164:167], v[32:47]
  ds_read_b128 v[100:103], v5 offset:256
  s_waitcnt lgkmcnt(5)
  v_mfma_f32_32x32x16_bf16 v[48:63], v[144:147], v[164:167], v[48:63]
  ds_read_b128 v[180:183], v6 offset:320
  s_waitcnt lgkmcnt(5)
  v_mfma_f32_32x32x16_bf16 v[32:47], v[132:135], v[168:171], v[32:47]
  ds_read_b128 v[152:155], v5 offset:352
  v_mfma_f32_32x32x16_bf16 v[48:63], v[140:143], v[168:171], v[48:63]
  ds_read_b128 v[96:99], v5 offset:288
  s_waitcnt lgkmcnt(6)
  v_mfma_f32_32x32x16_bf16 v[32:47], v[128:131], v[172:175], v[32:47]
  ds_read_b128 v[184:187], v6 offset:352
  v_mfma_f32_32x32x16_bf16 v[48:63], v[136:139], v[172:175], v[48:63]
  ds_read_b128 v[188:191], v6 offset:384
  s_waitcnt lgkmcnt(6)
  v_mfma_f32_32x32x16_bf16 v[32:47], v[156:159], v[176:179], v[32:47]
  ds_read_b128 v[160:163], v6 offset:144
  s_waitcnt lgkmcnt(6)
  v_mfma_f32_32x32x16_bf16 v[48:63], v[100:103], v[176:179], v[48:63]
  ds_read_b128 v[108:111], v5 offset:192
  s_waitcnt lgkmcnt(5)
  v_mfma_f32_32x32x16_bf16 v[32:47], v[152:155], v[180:183], v[32:47]
  ds_read_b128 v[116:119], v5 offset:128
  s_waitcnt lgkmcnt(5)
  v_mfma_f32_32x32x16_bf16 v[48:63], v[96:99], v[180:183], v[48:63]
  ds_read_b128 v[164:167], v6 offset:176
  s_waitcnt lgkmcnt(5)
  v_mfma_f32_32x32x16_bf16 v[32:47], v[148:151], v[184:187], v[32:47]
  ds_read_b128 v[104:107], v5 offset:224
  v_mfma_f32_32x32x16_bf16 v[48:63], v[156:159], v[184:187], v[48:63]
  ds_read_b128 v[112:115], v5 offset:160
  s_waitcnt lgkmcnt(6)
  v_mfma_f32_32x32x16_bf16 v[32:47], v[144:147], v[188:191], v[32:47]
  ds_read_b128 v[168:171], v6 offset:208
  v_mfma_f32_32x32x16_bf16 v[48:63], v[152:155], v[188:191], v[48:63]
  ds_read_b128 v[172:175], v6 offset:240
  s_waitcnt lgkmcnt(6)
  v_mfma_f32_32x32x16_bf16 v[32:47], v[108:111], v[160:163], v[32:47]
  ds_read_b128 v[176:179], v6 offset:0
  s_waitcnt lgkmcnt(6)
  v_mfma_f32_32x32x16_bf16 v[48:63], v[116:119], v[160:163], v[48:63]
  ds_read_b128 v[124:127], v5 offset:64
  s_waitcnt lgkmcnt(5)
  v_mfma_f32_32x32x16_bf16 v[32:47], v[104:107], v[164:167], v[32:47]
  ds_read_b128 v[132:135], v5 offset:0
  s_waitcnt lgkmcnt(5)
  v_mfma_f32_32x32x16_bf16 v[48:63], v[112:115], v[164:167], v[48:63]
  ds_read_b128 v[180:183], v6 offset:32
  s_waitcnt lgkmcnt(5)
  v_mfma_f32_32x32x16_bf16 v[32:47], v[100:103], v[168:171], v[32:47]
  ds_read_b128 v[120:123], v5 offset:96
  v_mfma_f32_32x32x16_bf16 v[48:63], v[108:111], v[168:171], v[48:63]
  ds_read_b128 v[128:131], v5 offset:32
  s_waitcnt lgkmcnt(6)
  v_mfma_f32_32x32x16_bf16 v[32:47], v[96:99], v[172:175], v[32:47]
  ds_read_b128 v[184:187], v6 offset:64
  v_mfma_f32_32x32x16_bf16 v[48:63], v[104:107], v[172:175], v[48:63]
  ds_read_b128 v[188:191], v6 offset:96
  s_waitcnt lgkmcnt(6)
  v_mfma_f32_32x32x16_bf16 v[32:47], v[124:127], v[176:179], v[32:47]
  ds_read_b128 v[160:163], v16 offset:1008
  ds_read_b128 v[148:151], v15 offset:960
  s_waitcnt lgkmcnt(7)
  v_mfma_f32_32x32x16_bf16 v[48:63], v[132:135], v[176:179], v[48:63]
  ds_read_b128 v[156:159], v15 offset:896
  s_waitcnt lgkmcnt(6)
  v_mfma_f32_32x32x16_bf16 v[32:47], v[120:123], v[180:183], v[32:47]
  ds_read_b128 v[164:167], v16 offset:1040
  s_waitcnt lgkmcnt(6)
  v_mfma_f32_32x32x16_bf16 v[48:63], v[128:131], v[180:183], v[48:63]
  ds_read_b128 v[144:147], v15 offset:992
  s_waitcnt lgkmcnt(6)
  v_mfma_f32_32x32x16_bf16 v[32:47], v[116:119], v[184:187], v[32:47]
  ds_read_b128 v[152:155], v15 offset:928
  ds_read_b128 v[168:171], v16 offset:1072
  v_mfma_f32_32x32x16_bf16 v[48:63], v[124:127], v[184:187], v[48:63]
  ds_read_b128 v[140:143], v15 offset:1024
  s_waitcnt lgkmcnt(8)
  v_mfma_f32_32x32x16_bf16 v[32:47], v[112:115], v[188:191], v[32:47]
  ds_read_b128 v[172:175], v16 offset:1104
  v_mfma_f32_32x32x16_bf16 v[48:63], v[120:123], v[188:191], v[48:63]
  ds_read_b128 v[136:139], v15 offset:1056
  s_barrier
  s_waitcnt lgkmcnt(8)
  v_mfma_f32_32x32x16_bf16 v[64:79], v[148:151], v[160:163], 0
  ds_read_b128 v[176:179], v16 offset:864
  s_waitcnt lgkmcnt(8)
  v_mfma_f32_32x32x16_bf16 v[80:95], v[156:159], v[160:163], 0
  ds_read_b128 v[100:103], v15 offset:832
  s_waitcnt lgkmcnt(7)
  v_mfma_f32_32x32x16_bf16 v[64:79], v[144:147], v[164:167], v[64:79]
  ds_read_b128 v[108:111], v15 offset:768
  s_waitcnt lgkmcnt(7)
  v_mfma_f32_32x32x16_bf16 v[80:95], v[152:155], v[164:167], v[80:95]
  ds_read_b128 v[180:183], v16 offset:896
  s_waitcnt lgkmcnt(6)
  v_mfma_f32_32x32x16_bf16 v[64:79], v[140:143], v[168:171], v[64:79]
  ds_read_b128 v[96:99], v15 offset:864
  v_mfma_f32_32x32x16_bf16 v[80:95], v[148:151], v[168:171], v[80:95]
  ds_read_b128 v[104:107], v15 offset:800
  s_waitcnt lgkmcnt(6)
  v_mfma_f32_32x32x16_bf16 v[64:79], v[136:139], v[172:175], v[64:79]
  ds_read_b128 v[184:187], v16 offset:928
  v_mfma_f32_32x32x16_bf16 v[80:95], v[144:147], v[172:175], v[80:95]
  ds_read_b128 v[188:191], v16 offset:960
  s_waitcnt lgkmcnt(6)
  v_mfma_f32_32x32x16_bf16 v[64:79], v[100:103], v[176:179], v[64:79]
  ds_read_b128 v[160:163], v16 offset:720
  ds_read_b128 v[116:119], v15 offset:704
  s_waitcnt lgkmcnt(7)
  v_mfma_f32_32x32x16_bf16 v[80:95], v[108:111], v[176:179], v[80:95]
  ds_read_b128 v[124:127], v15 offset:640
  ds_read_b128 v[164:167], v16 offset:752
  s_waitcnt lgkmcnt(7)
  v_mfma_f32_32x32x16_bf16 v[64:79], v[96:99], v[180:183], v[64:79]
  ds_read_b128 v[112:115], v15 offset:736
  ds_read_b128 v[120:123], v15 offset:672
  s_waitcnt lgkmcnt(8)
  v_mfma_f32_32x32x16_bf16 v[80:95], v[104:107], v[180:183], v[80:95]
  ds_read_b128 v[168:171], v16 offset:784
  ds_read_b128 v[172:175], v16 offset:816
  s_waitcnt lgkmcnt(9)
  v_mfma_f32_32x32x16_bf16 v[64:79], v[156:159], v[184:187], v[64:79]
  ds_write_b128 v10, v[32:35] offset:0
  ds_write_b128 v10, v[36:39] offset:1024
  v_mfma_f32_32x32x16_bf16 v[80:95], v[100:103], v[184:187], v[80:95]
  ds_write_b128 v10, v[40:43] offset:8192
  ds_write_b128 v10, v[44:47] offset:9216
  s_waitcnt lgkmcnt(12)
  v_mfma_f32_32x32x16_bf16 v[64:79], v[152:155], v[188:191], v[64:79]
  ds_write_b128 v10, v[48:51] offset:16384
  ds_write_b128 v10, v[52:55] offset:17408
  v_mfma_f32_32x32x16_bf16 v[80:95], v[96:99], v[188:191], v[80:95]
  ds_write_b128 v10, v[56:59] offset:24576
  ds_write_b128 v10, v[60:63] offset:25600
  s_waitcnt lgkmcnt(14)
  v_mfma_f32_32x32x16_bf16 v[64:79], v[116:119], v[160:163], v[64:79]
  ds_read_b128 v[176:179], v16 offset:576
  s_waitcnt lgkmcnt(14)
  v_mfma_f32_32x32x16_bf16 v[80:95], v[124:127], v[160:163], v[80:95]
  ds_read_b128 v[132:135], v15 offset:576
  s_waitcnt lgkmcnt(13)
  v_mfma_f32_32x32x16_bf16 v[64:79], v[112:115], v[164:167], v[64:79]
  ds_read_b128 v[140:143], v15 offset:512
  s_waitcnt lgkmcnt(13)
  v_mfma_f32_32x32x16_bf16 v[80:95], v[120:123], v[164:167], v[80:95]
  ds_read_b128 v[180:183], v16 offset:608
  s_waitcnt lgkmcnt(13)
  v_mfma_f32_32x32x16_bf16 v[64:79], v[108:111], v[168:171], v[64:79]
  ds_read_b128 v[128:131], v15 offset:608
  v_mfma_f32_32x32x16_bf16 v[80:95], v[116:119], v[168:171], v[80:95]
  ds_read_b128 v[136:139], v15 offset:544
  s_waitcnt lgkmcnt(14)
  v_mfma_f32_32x32x16_bf16 v[64:79], v[104:107], v[172:175], v[64:79]
  ds_read_b128 v[184:187], v16 offset:640
  v_mfma_f32_32x32x16_bf16 v[80:95], v[112:115], v[172:175], v[80:95]
  ds_read_b128 v[188:191], v16 offset:672
  s_waitcnt lgkmcnt(6)
  v_mfma_f32_32x32x16_bf16 v[64:79], v[132:135], v[176:179], v[64:79]
  ds_read_b128 v[160:163], v16 offset:432
  s_waitcnt lgkmcnt(6)
  v_mfma_f32_32x32x16_bf16 v[80:95], v[140:143], v[176:179], v[80:95]
  ds_read_b128 v[148:151], v15 offset:448
  s_waitcnt lgkmcnt(5)
  v_mfma_f32_32x32x16_bf16 v[64:79], v[128:131], v[180:183], v[64:79]
  ds_read_b128 v[156:159], v15 offset:384
  s_waitcnt lgkmcnt(5)
  v_mfma_f32_32x32x16_bf16 v[80:95], v[136:139], v[180:183], v[80:95]
  ds_read_b128 v[164:167], v16 offset:464
  s_waitcnt lgkmcnt(5)
  v_mfma_f32_32x32x16_bf16 v[64:79], v[124:127], v[184:187], v[64:79]
  ds_read_b128 v[144:147], v15 offset:480
  v_mfma_f32_32x32x16_bf16 v[80:95], v[132:135], v[184:187], v[80:95]
  ds_read_b128 v[152:155], v15 offset:416
  s_waitcnt lgkmcnt(6)
  v_mfma_f32_32x32x16_bf16 v[64:79], v[120:123], v[188:191], v[64:79]
  ds_read_b128 v[168:171], v16 offset:496
  v_mfma_f32_32x32x16_bf16 v[80:95], v[128:131], v[188:191], v[80:95]
  ds_read_b128 v[172:175], v16 offset:528
  s_barrier
  s_waitcnt lgkmcnt(6)
  v_mfma_f32_32x32x16_bf16 v[64:79], v[148:151], v[160:163], v[64:79]
  ds_read_b128 v[176:179], v16 offset:288
  s_waitcnt lgkmcnt(6)
  v_mfma_f32_32x32x16_bf16 v[80:95], v[156:159], v[160:163], v[80:95]
  ds_read_b128 v[100:103], v15 offset:320
  s_waitcnt lgkmcnt(5)
  v_mfma_f32_32x32x16_bf16 v[64:79], v[144:147], v[164:167], v[64:79]
  ds_read_b128 v[108:111], v15 offset:256
  s_waitcnt lgkmcnt(5)
  v_mfma_f32_32x32x16_bf16 v[80:95], v[152:155], v[164:167], v[80:95]
  ds_read_b128 v[180:183], v16 offset:320
  s_waitcnt lgkmcnt(5)
  v_mfma_f32_32x32x16_bf16 v[64:79], v[140:143], v[168:171], v[64:79]
  ds_read_b128 v[96:99], v15 offset:352
  v_mfma_f32_32x32x16_bf16 v[80:95], v[148:151], v[168:171], v[80:95]
  ds_read_b128 v[104:107], v15 offset:288
  s_waitcnt lgkmcnt(6)
  v_mfma_f32_32x32x16_bf16 v[64:79], v[136:139], v[172:175], v[64:79]
  ds_read_b128 v[184:187], v16 offset:352
  v_mfma_f32_32x32x16_bf16 v[80:95], v[144:147], v[172:175], v[80:95]
  ds_read_b128 v[188:191], v16 offset:384
  s_waitcnt lgkmcnt(6)
  v_mfma_f32_32x32x16_bf16 v[64:79], v[100:103], v[176:179], v[64:79]
  ds_read_b128 v[160:163], v16 offset:144
  s_waitcnt lgkmcnt(6)
  v_mfma_f32_32x32x16_bf16 v[80:95], v[108:111], v[176:179], v[80:95]
  ds_read_b128 v[116:119], v15 offset:192
  s_waitcnt lgkmcnt(5)
  v_mfma_f32_32x32x16_bf16 v[64:79], v[96:99], v[180:183], v[64:79]
  ds_read_b128 v[124:127], v15 offset:128
  s_waitcnt lgkmcnt(5)
  v_mfma_f32_32x32x16_bf16 v[80:95], v[104:107], v[180:183], v[80:95]
  ds_read_b128 v[164:167], v16 offset:176
  s_waitcnt lgkmcnt(5)
  v_mfma_f32_32x32x16_bf16 v[64:79], v[156:159], v[184:187], v[64:79]
  ds_read_b128 v[112:115], v15 offset:224
  v_mfma_f32_32x32x16_bf16 v[80:95], v[100:103], v[184:187], v[80:95]
  ds_read_b128 v[120:123], v15 offset:160
  s_waitcnt lgkmcnt(6)
  v_mfma_f32_32x32x16_bf16 v[64:79], v[152:155], v[188:191], v[64:79]
  ds_read_b128 v[168:171], v16 offset:208
  v_mfma_f32_32x32x16_bf16 v[80:95], v[96:99], v[188:191], v[80:95]
  ds_read_b128 v[172:175], v16 offset:240
  s_waitcnt lgkmcnt(6)
  v_mfma_f32_32x32x16_bf16 v[64:79], v[116:119], v[160:163], v[64:79]
  ds_read_b128 v[176:179], v16 offset:0
  s_waitcnt lgkmcnt(6)
  v_mfma_f32_32x32x16_bf16 v[80:95], v[124:127], v[160:163], v[80:95]
  ds_read_b128 v[132:135], v15 offset:64
  s_waitcnt lgkmcnt(5)
  v_mfma_f32_32x32x16_bf16 v[64:79], v[112:115], v[164:167], v[64:79]
  ds_read_b128 v[140:143], v15 offset:0
  s_waitcnt lgkmcnt(5)
  v_mfma_f32_32x32x16_bf16 v[80:95], v[120:123], v[164:167], v[80:95]
  ds_read_b128 v[180:183], v16 offset:32
  s_waitcnt lgkmcnt(5)
  v_mfma_f32_32x32x16_bf16 v[64:79], v[108:111], v[168:171], v[64:79]
  ds_read_b128 v[128:131], v15 offset:96
  v_mfma_f32_32x32x16_bf16 v[80:95], v[116:119], v[168:171], v[80:95]
  ds_read_b128 v[136:139], v15 offset:32
  s_waitcnt lgkmcnt(6)
  v_mfma_f32_32x32x16_bf16 v[64:79], v[104:107], v[172:175], v[64:79]
  ds_read_b128 v[184:187], v16 offset:64
  v_mfma_f32_32x32x16_bf16 v[80:95], v[112:115], v[172:175], v[80:95]
  ds_read_b128 v[188:191], v16 offset:96
  s_waitcnt lgkmcnt(6)
  v_mfma_f32_32x32x16_bf16 v[64:79], v[132:135], v[176:179], v[64:79]
  ds_read_b128 v[160:163], v6 offset:1008
  ds_read_b128 v[156:159], v5 offset:960
  s_waitcnt lgkmcnt(7)
  v_mfma_f32_32x32x16_bf16 v[80:95], v[140:143], v[176:179], v[80:95]
  ds_read_b128 v[100:103], v5 offset:896
  s_waitcnt lgkmcnt(6)
  v_mfma_f32_32x32x16_bf16 v[64:79], v[128:131], v[180:183], v[64:79]
  ds_read_b128 v[164:167], v6 offset:1040
  s_waitcnt lgkmcnt(6)
  v_mfma_f32_32x32x16_bf16 v[80:95], v[136:139], v[180:183], v[80:95]
  ds_read_b128 v[152:155], v5 offset:992
  s_waitcnt lgkmcnt(6)
  v_mfma_f32_32x32x16_bf16 v[64:79], v[124:127], v[184:187], v[64:79]
  ds_read_b128 v[96:99], v5 offset:928
  ds_read_b128 v[168:171], v6 offset:1072
  v_mfma_f32_32x32x16_bf16 v[80:95], v[132:135], v[184:187], v[80:95]
  ds_read_b128 v[148:151], v5 offset:1024
  s_waitcnt lgkmcnt(8)
  v_mfma_f32_32x32x16_bf16 v[64:79], v[120:123], v[188:191], v[64:79]
  ds_read_b128 v[172:175], v6 offset:1104
  v_mfma_f32_32x32x16_bf16 v[80:95], v[128:131], v[188:191], v[80:95]
  ds_read_b128 v[144:147], v5 offset:1056
  s_barrier
  s_waitcnt lgkmcnt(8)
  v_mfma_f32_32x32x16_bf16 v[32:47], v[156:159], v[160:163], 0
  ds_read_b128 v[176:179], v6 offset:864
  s_waitcnt lgkmcnt(8)
  v_mfma_f32_32x32x16_bf16 v[48:63], v[100:103], v[160:163], 0
  ds_read_b128 v[108:111], v5 offset:832
  s_waitcnt lgkmcnt(7)
  v_mfma_f32_32x32x16_bf16 v[32:47], v[152:155], v[164:167], v[32:47]
  ds_read_b128 v[116:119], v5 offset:768
  s_waitcnt lgkmcnt(7)
  v_mfma_f32_32x32x16_bf16 v[48:63], v[96:99], v[164:167], v[48:63]
  ds_read_b128 v[180:183], v6 offset:896
  s_waitcnt lgkmcnt(6)
  v_mfma_f32_32x32x16_bf16 v[32:47], v[148:151], v[168:171], v[32:47]
  ds_read_b128 v[104:107], v5 offset:864
  v_mfma_f32_32x32x16_bf16 v[48:63], v[156:159], v[168:171], v[48:63]
  ds_read_b128 v[112:115], v5 offset:800
  s_waitcnt lgkmcnt(6)
  v_mfma_f32_32x32x16_bf16 v[32:47], v[144:147], v[172:175], v[32:47]
  ds_read_b128 v[184:187], v6 offset:928
  v_mfma_f32_32x32x16_bf16 v[48:63], v[152:155], v[172:175], v[48:63]
  ds_read_b128 v[188:191], v6 offset:960
  s_waitcnt lgkmcnt(6)
  v_mfma_f32_32x32x16_bf16 v[32:47], v[108:111], v[176:179], v[32:47]
  ds_read_b128 v[160:163], v6 offset:720
  ds_read_b128 v[124:127], v5 offset:704
  s_waitcnt lgkmcnt(7)
  v_mfma_f32_32x32x16_bf16 v[48:63], v[116:119], v[176:179], v[48:63]
  ds_read_b128 v[132:135], v5 offset:640
  ds_read_b128 v[164:167], v6 offset:752
  s_waitcnt lgkmcnt(7)
  v_mfma_f32_32x32x16_bf16 v[32:47], v[104:107], v[180:183], v[32:47]
  ds_read_b128 v[120:123], v5 offset:736
  ds_read_b128 v[128:131], v5 offset:672
  s_waitcnt lgkmcnt(8)
  v_mfma_f32_32x32x16_bf16 v[48:63], v[112:115], v[180:183], v[48:63]
  ds_read_b128 v[168:171], v6 offset:784
  ds_read_b128 v[172:175], v6 offset:816
  s_waitcnt lgkmcnt(9)
  v_mfma_f32_32x32x16_bf16 v[32:47], v[100:103], v[184:187], v[32:47]
  ds_write_b128 v10, v[64:67] offset:0
  ds_write_b128 v10, v[68:71] offset:1024
  v_mfma_f32_32x32x16_bf16 v[48:63], v[108:111], v[184:187], v[48:63]
  ds_write_b128 v10, v[72:75] offset:8192
  ds_write_b128 v10, v[76:79] offset:9216
  s_waitcnt lgkmcnt(12)
  v_mfma_f32_32x32x16_bf16 v[32:47], v[96:99], v[188:191], v[32:47]
  ds_write_b128 v10, v[80:83] offset:16384
  ds_write_b128 v10, v[84:87] offset:17408
  v_mfma_f32_32x32x16_bf16 v[48:63], v[104:107], v[188:191], v[48:63]
  ds_write_b128 v10, v[88:91] offset:24576
  ds_write_b128 v10, v[92:95] offset:25600
  s_waitcnt lgkmcnt(14)
  v_mfma_f32_32x32x16_bf16 v[32:47], v[124:127], v[160:163], v[32:47]
  ds_read_b128 v[176:179], v6 offset:576
  s_waitcnt lgkmcnt(14)
  v_mfma_f32_32x32x16_bf16 v[48:63], v[132:135], v[160:163], v[48:63]
  ds_read_b128 v[140:143], v5 offset:576
  s_waitcnt lgkmcnt(13)
  v_mfma_f32_32x32x16_bf16 v[32:47], v[120:123], v[164:167], v[32:47]
  ds_read_b128 v[148:151], v5 offset:512
  s_waitcnt lgkmcnt(13)
  v_mfma_f32_32x32x16_bf16 v[48:63], v[128:131], v[164:167], v[48:63]
  ds_read_b128 v[180:183], v6 offset:608
  s_waitcnt lgkmcnt(13)
  v_mfma_f32_32x32x16_bf16 v[32:47], v[116:119], v[168:171], v[32:47]
  ds_read_b128 v[136:139], v5 offset:608
  v_mfma_f32_32x32x16_bf16 v[48:63], v[124:127], v[168:171], v[48:63]
  ds_read_b128 v[144:147], v5 offset:544
  s_waitcnt lgkmcnt(14)
  v_mfma_f32_32x32x16_bf16 v[32:47], v[112:115], v[172:175], v[32:47]
  ds_read_b128 v[184:187], v6 offset:640
  v_mfma_f32_32x32x16_bf16 v[48:63], v[120:123], v[172:175], v[48:63]
  ds_read_b128 v[188:191], v6 offset:672
  s_waitcnt lgkmcnt(6)
  v_mfma_f32_32x32x16_bf16 v[32:47], v[140:143], v[176:179], v[32:47]
  ds_read_b128 v[160:163], v6 offset:432
  s_waitcnt lgkmcnt(6)
  v_mfma_f32_32x32x16_bf16 v[48:63], v[148:151], v[176:179], v[48:63]
  ds_read_b128 v[156:159], v5 offset:448
  s_waitcnt lgkmcnt(5)
  v_mfma_f32_32x32x16_bf16 v[32:47], v[136:139], v[180:183], v[32:47]
  ds_read_b128 v[100:103], v5 offset:384
  s_waitcnt lgkmcnt(5)
  v_mfma_f32_32x32x16_bf16 v[48:63], v[144:147], v[180:183], v[48:63]
  ds_read_b128 v[164:167], v6 offset:464
  s_waitcnt lgkmcnt(5)
  v_mfma_f32_32x32x16_bf16 v[32:47], v[132:135], v[184:187], v[32:47]
  ds_read_b128 v[152:155], v5 offset:480
  v_mfma_f32_32x32x16_bf16 v[48:63], v[140:143], v[184:187], v[48:63]
  ds_read_b128 v[96:99], v5 offset:416
  s_waitcnt lgkmcnt(6)
  v_mfma_f32_32x32x16_bf16 v[32:47], v[128:131], v[188:191], v[32:47]
  ds_read_b128 v[168:171], v6 offset:496
  v_mfma_f32_32x32x16_bf16 v[48:63], v[136:139], v[188:191], v[48:63]
  ds_read_b128 v[172:175], v6 offset:528
  s_barrier
  s_waitcnt lgkmcnt(6)
  v_mfma_f32_32x32x16_bf16 v[32:47], v[156:159], v[160:163], v[32:47]
  ds_read_b128 v[176:179], v6 offset:288
  s_waitcnt lgkmcnt(6)
  v_mfma_f32_32x32x16_bf16 v[48:63], v[100:103], v[160:163], v[48:63]
  ds_read_b128 v[108:111], v5 offset:320
  s_waitcnt lgkmcnt(5)
  v_mfma_f32_32x32x16_bf16 v[32:47], v[152:155], v[164:167], v[32:47]
  ds_read_b128 v[116:119], v5 offset:256
  s_waitcnt lgkmcnt(5)
  v_mfma_f32_32x32x16_bf16 v[48:63], v[96:99], v[164:167], v[48:63]
  ds_read_b128 v[180:183], v6 offset:320
  s_waitcnt lgkmcnt(5)
  v_mfma_f32_32x32x16_bf16 v[32:47], v[148:151], v[168:171], v[32:47]
  ds_read_b128 v[104:107], v5 offset:352
  v_mfma_f32_32x32x16_bf16 v[48:63], v[156:159], v[168:171], v[48:63]
  ds_read_b128 v[112:115], v5 offset:288
  s_waitcnt lgkmcnt(6)
  v_mfma_f32_32x32x16_bf16 v[32:47], v[144:147], v[172:175], v[32:47]
  ds_read_b128 v[184:187], v6 offset:352
  v_mfma_f32_32x32x16_bf16 v[48:63], v[152:155], v[172:175], v[48:63]
  ds_read_b128 v[188:191], v6 offset:384
  s_waitcnt lgkmcnt(6)
  v_mfma_f32_32x32x16_bf16 v[32:47], v[108:111], v[176:179], v[32:47]
  ds_read_b128 v[160:163], v6 offset:144
  s_waitcnt lgkmcnt(6)
  v_mfma_f32_32x32x16_bf16 v[48:63], v[116:119], v[176:179], v[48:63]
  ds_read_b128 v[124:127], v5 offset:192
  s_waitcnt lgkmcnt(5)
  v_mfma_f32_32x32x16_bf16 v[32:47], v[104:107], v[180:183], v[32:47]
  ds_read_b128 v[132:135], v5 offset:128
  s_waitcnt lgkmcnt(5)
  v_mfma_f32_32x32x16_bf16 v[48:63], v[112:115], v[180:183], v[48:63]
  ds_read_b128 v[164:167], v6 offset:176
  s_waitcnt lgkmcnt(5)
  v_mfma_f32_32x32x16_bf16 v[32:47], v[100:103], v[184:187], v[32:47]
  ds_read_b128 v[120:123], v5 offset:224
  v_mfma_f32_32x32x16_bf16 v[48:63], v[108:111], v[184:187], v[48:63]
  ds_read_b128 v[128:131], v5 offset:160
  s_waitcnt lgkmcnt(6)
  v_mfma_f32_32x32x16_bf16 v[32:47], v[96:99], v[188:191], v[32:47]
  ds_read_b128 v[168:171], v6 offset:208
  v_mfma_f32_32x32x16_bf16 v[48:63], v[104:107], v[188:191], v[48:63]
  ds_read_b128 v[172:175], v6 offset:240
  s_waitcnt lgkmcnt(6)
  v_mfma_f32_32x32x16_bf16 v[32:47], v[124:127], v[160:163], v[32:47]
  ds_read_b128 v[176:179], v6 offset:0
  s_waitcnt lgkmcnt(6)
  v_mfma_f32_32x32x16_bf16 v[48:63], v[132:135], v[160:163], v[48:63]
  ds_read_b128 v[140:143], v5 offset:64
  s_waitcnt lgkmcnt(5)
  v_mfma_f32_32x32x16_bf16 v[32:47], v[120:123], v[164:167], v[32:47]
  ds_read_b128 v[148:151], v5 offset:0
  s_waitcnt lgkmcnt(5)
  v_mfma_f32_32x32x16_bf16 v[48:63], v[128:131], v[164:167], v[48:63]
  ds_read_b128 v[180:183], v6 offset:32
  s_waitcnt lgkmcnt(5)
  v_mfma_f32_32x32x16_bf16 v[32:47], v[116:119], v[168:171], v[32:47]
  ds_read_b128 v[136:139], v5 offset:96
  v_mfma_f32_32x32x16_bf16 v[48:63], v[124:127], v[168:171], v[48:63]
  ds_read_b128 v[144:147], v5 offset:32
  s_waitcnt lgkmcnt(6)
  v_mfma_f32_32x32x16_bf16 v[32:47], v[112:115], v[172:175], v[32:47]
  ds_read_b128 v[184:187], v6 offset:64
  v_mfma_f32_32x32x16_bf16 v[48:63], v[120:123], v[172:175], v[48:63]
  ds_read_b128 v[188:191], v6 offset:96
  s_waitcnt lgkmcnt(6)
  v_mfma_f32_32x32x16_bf16 v[32:47], v[140:143], v[176:179], v[32:47]
  ds_read_b128 v[160:163], v16 offset:1008
  ds_read_b128 v[100:103], v15 offset:960
  s_waitcnt lgkmcnt(7)
  v_mfma_f32_32x32x16_bf16 v[48:63], v[148:151], v[176:179], v[48:63]
  ds_read_b128 v[108:111], v15 offset:896
  s_waitcnt lgkmcnt(6)
  v_mfma_f32_32x32x16_bf16 v[32:47], v[136:139], v[180:183], v[32:47]
  ds_read_b128 v[164:167], v16 offset:1040
  s_waitcnt lgkmcnt(6)
  v_mfma_f32_32x32x16_bf16 v[48:63], v[144:147], v[180:183], v[48:63]
  ds_read_b128 v[96:99], v15 offset:992
  s_waitcnt lgkmcnt(6)
  v_mfma_f32_32x32x16_bf16 v[32:47], v[132:135], v[184:187], v[32:47]
  ds_read_b128 v[104:107], v15 offset:928
  ds_read_b128 v[168:171], v16 offset:1072
  v_mfma_f32_32x32x16_bf16 v[48:63], v[140:143], v[184:187], v[48:63]
  ds_read_b128 v[156:159], v15 offset:1024
  s_waitcnt lgkmcnt(8)
  v_mfma_f32_32x32x16_bf16 v[32:47], v[128:131], v[188:191], v[32:47]
  ds_read_b128 v[172:175], v16 offset:1104
  v_mfma_f32_32x32x16_bf16 v[48:63], v[136:139], v[188:191], v[48:63]
  ds_read_b128 v[152:155], v15 offset:1056
  s_barrier
  s_waitcnt lgkmcnt(8)
  v_mfma_f32_32x32x16_bf16 v[64:79], v[100:103], v[160:163], 0
  ds_read_b128 v[176:179], v16 offset:864
  s_waitcnt lgkmcnt(8)
  v_mfma_f32_32x32x16_bf16 v[80:95], v[108:111], v[160:163], 0
  ds_read_b128 v[116:119], v15 offset:832
  s_waitcnt lgkmcnt(7)
  v_mfma_f32_32x32x16_bf16 v[64:79], v[96:99], v[164:167], v[64:79]
  ds_read_b128 v[124:127], v15 offset:768
  s_waitcnt lgkmcnt(7)
  v_mfma_f32_32x32x16_bf16 v[80:95], v[104:107], v[164:167], v[80:95]
  ds_read_b128 v[180:183], v16 offset:896
  s_waitcnt lgkmcnt(6)
  v_mfma_f32_32x32x16_bf16 v[64:79], v[156:159], v[168:171], v[64:79]
  ds_read_b128 v[112:115], v15 offset:864
  v_mfma_f32_32x32x16_bf16 v[80:95], v[100:103], v[168:171], v[80:95]
  ds_read_b128 v[120:123], v15 offset:800
  s_waitcnt lgkmcnt(6)
  v_mfma_f32_32x32x16_bf16 v[64:79], v[152:155], v[172:175], v[64:79]
  ds_read_b128 v[184:187], v16 offset:928
  v_mfma_f32_32x32x16_bf16 v[80:95], v[96:99], v[172:175], v[80:95]
  ds_read_b128 v[188:191], v16 offset:960
  s_waitcnt lgkmcnt(6)
  v_mfma_f32_32x32x16_bf16 v[64:79], v[116:119], v[176:179], v[64:79]
  ds_read_b128 v[160:163], v16 offset:720
  ds_read_b128 v[132:135], v15 offset:704
  s_waitcnt lgkmcnt(7)
  v_mfma_f32_32x32x16_bf16 v[80:95], v[124:127], v[176:179], v[80:95]
  ds_read_b128 v[140:143], v15 offset:640
  ds_read_b128 v[164:167], v16 offset:752
  s_waitcnt lgkmcnt(7)
  v_mfma_f32_32x32x16_bf16 v[64:79], v[112:115], v[180:183], v[64:79]
  ds_read_b128 v[128:131], v15 offset:736
  ds_read_b128 v[136:139], v15 offset:672
  s_waitcnt lgkmcnt(8)
  v_mfma_f32_32x32x16_bf16 v[80:95], v[120:123], v[180:183], v[80:95]
  ds_read_b128 v[168:171], v16 offset:784
  ds_read_b128 v[172:175], v16 offset:816
  s_waitcnt lgkmcnt(9)
  v_mfma_f32_32x32x16_bf16 v[64:79], v[108:111], v[184:187], v[64:79]
  ds_write_b128 v10, v[32:35] offset:0
  ds_write_b128 v10, v[36:39] offset:1024
  v_mfma_f32_32x32x16_bf16 v[80:95], v[116:119], v[184:187], v[80:95]
  ds_write_b128 v10, v[40:43] offset:8192
  ds_write_b128 v10, v[44:47] offset:9216
  s_waitcnt lgkmcnt(12)
  v_mfma_f32_32x32x16_bf16 v[64:79], v[104:107], v[188:191], v[64:79]
  ds_write_b128 v10, v[48:51] offset:16384
  ds_write_b128 v10, v[52:55] offset:17408
  v_mfma_f32_32x32x16_bf16 v[80:95], v[112:115], v[188:191], v[80:95]
  ds_write_b128 v10, v[56:59] offset:24576
  ds_write_b128 v10, v[60:63] offset:25600
  s_waitcnt lgkmcnt(14)
  v_mfma_f32_32x32x16_bf16 v[64:79], v[132:135], v[160:163], v[64:79]
  ds_read_b128 v[176:179], v16 offset:576
  s_waitcnt lgkmcnt(14)
  v_mfma_f32_32x32x16_bf16 v[80:95], v[140:143], v[160:163], v[80:95]
  ds_read_b128 v[148:151], v15 offset:576
  s_waitcnt lgkmcnt(13)
  v_mfma_f32_32x32x16_bf16 v[64:79], v[128:131], v[164:167], v[64:79]
  ds_read_b128 v[156:159], v15 offset:512
  s_waitcnt lgkmcnt(13)
  v_mfma_f32_32x32x16_bf16 v[80:95], v[136:139], v[164:167], v[80:95]
  ds_read_b128 v[180:183], v16 offset:608
  s_waitcnt lgkmcnt(13)
  v_mfma_f32_32x32x16_bf16 v[64:79], v[124:127], v[168:171], v[64:79]
  ds_read_b128 v[144:147], v15 offset:608
  v_mfma_f32_32x32x16_bf16 v[80:95], v[132:135], v[168:171], v[80:95]
  ds_read_b128 v[152:155], v15 offset:544
  s_waitcnt lgkmcnt(14)
  v_mfma_f32_32x32x16_bf16 v[64:79], v[120:123], v[172:175], v[64:79]
  ds_read_b128 v[184:187], v16 offset:640
  v_mfma_f32_32x32x16_bf16 v[80:95], v[128:131], v[172:175], v[80:95]
  ds_read_b128 v[188:191], v16 offset:672
  s_waitcnt lgkmcnt(6)
  v_mfma_f32_32x32x16_bf16 v[64:79], v[148:151], v[176:179], v[64:79]
  ds_read_b128 v[160:163], v16 offset:432
  s_waitcnt lgkmcnt(6)
  v_mfma_f32_32x32x16_bf16 v[80:95], v[156:159], v[176:179], v[80:95]
  ds_read_b128 v[100:103], v15 offset:448
  s_waitcnt lgkmcnt(5)
  v_mfma_f32_32x32x16_bf16 v[64:79], v[144:147], v[180:183], v[64:79]
  ds_read_b128 v[108:111], v15 offset:384
  s_waitcnt lgkmcnt(5)
  v_mfma_f32_32x32x16_bf16 v[80:95], v[152:155], v[180:183], v[80:95]
  ds_read_b128 v[164:167], v16 offset:464
  s_waitcnt lgkmcnt(5)
  v_mfma_f32_32x32x16_bf16 v[64:79], v[140:143], v[184:187], v[64:79]
  ds_read_b128 v[96:99], v15 offset:480
  v_mfma_f32_32x32x16_bf16 v[80:95], v[148:151], v[184:187], v[80:95]
  ds_read_b128 v[104:107], v15 offset:416
  s_waitcnt lgkmcnt(6)
  v_mfma_f32_32x32x16_bf16 v[64:79], v[136:139], v[188:191], v[64:79]
  ds_read_b128 v[168:171], v16 offset:496
  v_mfma_f32_32x32x16_bf16 v[80:95], v[144:147], v[188:191], v[80:95]
  ds_read_b128 v[172:175], v16 offset:528
  s_barrier
  s_waitcnt lgkmcnt(6)
  v_mfma_f32_32x32x16_bf16 v[64:79], v[100:103], v[160:163], v[64:79]
  ds_read_b128 v[176:179], v16 offset:288
  s_waitcnt lgkmcnt(6)
  v_mfma_f32_32x32x16_bf16 v[80:95], v[108:111], v[160:163], v[80:95]
  ds_read_b128 v[116:119], v15 offset:320
  s_waitcnt lgkmcnt(5)
  v_mfma_f32_32x32x16_bf16 v[64:79], v[96:99], v[164:167], v[64:79]
  ds_read_b128 v[124:127], v15 offset:256
  s_waitcnt lgkmcnt(5)
  v_mfma_f32_32x32x16_bf16 v[80:95], v[104:107], v[164:167], v[80:95]
  ds_read_b128 v[180:183], v16 offset:320
  s_waitcnt lgkmcnt(5)
  v_mfma_f32_32x32x16_bf16 v[64:79], v[156:159], v[168:171], v[64:79]
  ds_read_b128 v[112:115], v15 offset:352
  v_mfma_f32_32x32x16_bf16 v[80:95], v[100:103], v[168:171], v[80:95]
  ds_read_b128 v[120:123], v15 offset:288
  s_waitcnt lgkmcnt(6)
  v_mfma_f32_32x32x16_bf16 v[64:79], v[152:155], v[172:175], v[64:79]
  ds_read_b128 v[184:187], v16 offset:352
  v_mfma_f32_32x32x16_bf16 v[80:95], v[96:99], v[172:175], v[80:95]
  ds_read_b128 v[188:191], v16 offset:384
  s_waitcnt lgkmcnt(6)
  v_mfma_f32_32x32x16_bf16 v[64:79], v[116:119], v[176:179], v[64:79]
  ds_read_b128 v[160:163], v16 offset:144
  s_waitcnt lgkmcnt(6)
  v_mfma_f32_32x32x16_bf16 v[80:95], v[124:127], v[176:179], v[80:95]
  ds_read_b128 v[132:135], v15 offset:192
  s_waitcnt lgkmcnt(5)
  v_mfma_f32_32x32x16_bf16 v[64:79], v[112:115], v[180:183], v[64:79]
  ds_read_b128 v[140:143], v15 offset:128
  s_waitcnt lgkmcnt(5)
  v_mfma_f32_32x32x16_bf16 v[80:95], v[120:123], v[180:183], v[80:95]
  ds_read_b128 v[164:167], v16 offset:176
  s_waitcnt lgkmcnt(5)
  v_mfma_f32_32x32x16_bf16 v[64:79], v[108:111], v[184:187], v[64:79]
  ds_read_b128 v[128:131], v15 offset:224
  v_mfma_f32_32x32x16_bf16 v[80:95], v[116:119], v[184:187], v[80:95]
  ds_read_b128 v[136:139], v15 offset:160
  s_waitcnt lgkmcnt(6)
  v_mfma_f32_32x32x16_bf16 v[64:79], v[104:107], v[188:191], v[64:79]
  ds_read_b128 v[168:171], v16 offset:208
  v_mfma_f32_32x32x16_bf16 v[80:95], v[112:115], v[188:191], v[80:95]
  ds_read_b128 v[172:175], v16 offset:240
  s_waitcnt lgkmcnt(6)
  v_mfma_f32_32x32x16_bf16 v[64:79], v[132:135], v[160:163], v[64:79]
  ds_read_b128 v[176:179], v16 offset:0
  s_waitcnt lgkmcnt(6)
  v_mfma_f32_32x32x16_bf16 v[80:95], v[140:143], v[160:163], v[80:95]
  ds_read_b128 v[148:151], v15 offset:64
  s_waitcnt lgkmcnt(5)
  v_mfma_f32_32x32x16_bf16 v[64:79], v[128:131], v[164:167], v[64:79]
  ds_read_b128 v[156:159], v15 offset:0
  s_waitcnt lgkmcnt(5)
  v_mfma_f32_32x32x16_bf16 v[80:95], v[136:139], v[164:167], v[80:95]
  ds_read_b128 v[180:183], v16 offset:32
  s_waitcnt lgkmcnt(5)
  v_mfma_f32_32x32x16_bf16 v[64:79], v[124:127], v[168:171], v[64:79]
  ds_read_b128 v[144:147], v15 offset:96
  v_mfma_f32_32x32x16_bf16 v[80:95], v[132:135], v[168:171], v[80:95]
  ds_read_b128 v[152:155], v15 offset:32
  s_waitcnt lgkmcnt(6)
  v_mfma_f32_32x32x16_bf16 v[64:79], v[120:123], v[172:175], v[64:79]
  ds_read_b128 v[184:187], v16 offset:64
  v_mfma_f32_32x32x16_bf16 v[80:95], v[128:131], v[172:175], v[80:95]
  ds_read_b128 v[188:191], v16 offset:96
  s_waitcnt lgkmcnt(6)
  v_mfma_f32_32x32x16_bf16 v[64:79], v[148:151], v[176:179], v[64:79]
  s_waitcnt lgkmcnt(5)
  v_mfma_f32_32x32x16_bf16 v[80:95], v[156:159], v[176:179], v[80:95]
  s_waitcnt lgkmcnt(3)
  v_mfma_f32_32x32x16_bf16 v[64:79], v[144:147], v[180:183], v[64:79]
  s_waitcnt lgkmcnt(2)
  v_mfma_f32_32x32x16_bf16 v[80:95], v[152:155], v[180:183], v[80:95]
  s_waitcnt lgkmcnt(1)
  v_mfma_f32_32x32x16_bf16 v[64:79], v[140:143], v[184:187], v[64:79]
  v_mfma_f32_32x32x16_bf16 v[80:95], v[148:151], v[184:187], v[80:95]
  s_waitcnt lgkmcnt(0)
  v_mfma_f32_32x32x16_bf16 v[64:79], v[136:139], v[188:191], v[64:79]
  v_mfma_f32_32x32x16_bf16 v[80:95], v[144:147], v[188:191], v[80:95]
  s_barrier
  s_nop 7
  s_nop 3
  ds_write_b128 v10, v[64:67] offset:0
  ds_write_b128 v10, v[68:71] offset:1024
  ds_write_b128 v10, v[72:75] offset:8192
  ds_write_b128 v10, v[76:79] offset:9216
  ds_write_b128 v10, v[80:83] offset:16384
  ds_write_b128 v10, v[84:87] offset:17408
  ds_write_b128 v10, v[88:91] offset:24576
  ds_write_b128 v10, v[92:95] offset:25600
  s_waitcnt lgkmcnt(0)
  s_barrier
  s_branch L_k2_final
L_k2_helper:
  v_cmp_eq_u32 s[66:67], 0, v0
  v_lshlrev_b32 v7, 4, v0
  v_lshrrev_b32 v14, 3, v0
  v_mul_u32_u24 v8, 144, v14
  v_and_b32 v14, 7, v0
  v_lshl_add_u32 v8, v14, 4, v8
  v_add_u32 v8, 75120, v8
  v_sub_u32 v9, 255, v0
  v_lshlrev_b32 v9, 4, v9
  v_lshlrev_b32 v11, 13, v2
  v_lshl_add_u32 v11, v1, 4, v11
  v_add_u32 v11, 88800, v11
  v_lshlrev_b32 v14, 6, v3
  v_lshl_add_u32 v14, v2, 4, v14
  v_lshl_add_u32 v14, v4, 2, v14
  v_lshlrev_b32 v12, 1, v14
  v_lshlrev_b32 v13, 4, v14
  v_lshl_add_u32 v13, v3, 4, v13
  v_add_u32 v13, 121568, v13
  s_cmp_eq_u32 s41, 0
  s_cselect_b64 s[76:77], -1, 0
  s_add_u32 s74, s70, 0
  s_lshl_b32 s74, s74, 12
  v_add_u32 v14, s74, v7
  v_subrev_u32 v15, 16, v14
  buffer_load_dwordx4 v[168:171], v14, s[44:47], 0 offen
  buffer_load_dwordx4 v[172:175], v15, s[44:47], 0 offen
  buffer_load_dwordx4 v[176:179], v14, s[48:51], 0 offen
  v_mov_b32 v16, 0
  v_mov_b32 v17, 0
  v_mov_b32 v18, 0
  v_mov_b32 v19, 0
  v_cmp_gt_u32 vcc, 128, v0
  s_and_saveexec_b64 s[68:69], vcc
  v_lshrrev_b32 v14, 3, v0
  v_mul_u32_u24 v14, 4416, v14
  v_and_b32 v15, 7, v0
  v_lshl_add_u32 v14, v15, 4, v14
  ds_write_b128 v14, v[16:19] offset:4096
  s_mov_b64 exec, s[68:69]
  v_lshlrev_b32 v14, 4, v0
  v_add_u32 v14, 70656, v14
  ds_write_b128 v14, v[16:19] offset:0
  ds_write_b128 v14, v[16:19] offset:9072
  v_cmp_gt_u32 vcc, 23, v0
  s_and_saveexec_b64 s[68:69], vcc
  ds_write_b128 v14, v[16:19] offset:4096
  ds_write_b128 v14, v[16:19] offset:13168
  s_mov_b64 exec, s[68:69]
  s_waitcnt vmcnt(0)
  v_cndmask_b32 v172, v172, 0, s[66:67]
  v_cndmask_b32 v173, v173, 0, s[66:67]
  v_cndmask_b32 v174, v174, 0, s[66:67]
  v_cndmask_b32 v175, v175, 0, s[66:67]
  ds_write_b128 v8, v[176:179]
  v_alignbit_b32 v180, v171, v171, 16
  v_bfi_b32 v196, s65, v171, v170
  v_alignbit_b32 v181, v170, v170, 16
  v_bfi_b32 v197, s65, v170, v169
  v_alignbit_b32 v182, v169, v169, 16
  v_bfi_b32 v198, s65, v169, v168
  v_alignbit_b32 v183, v168, v168, 16
  v_bfi_b32 v199, s65, v168, v175
  v_alignbit_b32 v184, v175, v175, 16
  v_bfi_b32 v200, s65, v175, v174
  v_alignbit_b32 v185, v174, v174, 16
  v_bfi_b32 v201, s65, v174, v173
  v_alignbit_b32 v186, v173, v173, 16
  v_bfi_b32 v202, s65, v173, v172
  v_mov_b32 v188, v181
  v_mov_b32 v204, v197
  v_mov_b32 v189, v182
  v_mov_b32 v205, v198
  v_mov_b32 v190, v183
  v_mov_b32 v206, v199
  v_mov_b32 v191, v184
  v_mov_b32 v207, v200
  v_mov_b32 v192, v185
  v_mov_b32 v208, v201
  v_mov_b32 v193, v186
  v_mov_b32 v209, v202
  ds_write_b128 v9, v[180:183] offset:0
  ds_write_b128 v9, v[196:199] offset:4416
  ds_write_b128 v9, v[188:191] offset:8832
  ds_write_b128 v9, v[204:207] offset:13248
  ds_write_b128 v9, v[182:185] offset:17664
  ds_write_b128 v9, v[198:201] offset:22080
  ds_write_b128 v9, v[190:193] offset:26496
  ds_write_b128 v9, v[206:209] offset:30912
  v_add_u32 v9, s72, v9
  v_add_u32 v8, s73, v8
  s_sub_u32 s72, 0, s72
  s_sub_u32 s73, 0, s73
  s_add_u32 s74, s70, 1
  s_lshl_b32 s74, s74, 12
  v_add_u32 v14, s74, v7
  v_subrev_u32 v15, 16, v14
  buffer_load_dwordx4 v[168:171], v14, s[44:47], 0 offen
  buffer_load_dwordx4 v[172:175], v15, s[44:47], 0 offen
  buffer_load_dwordx4 v[176:179], v14, s[48:51], 0 offen
  s_waitcnt lgkmcnt(0)
  s_barrier
L_k2_hloop:
  s_waitcnt vmcnt(0)
  s_cmp_eq_u32 s71, 7
  s_cbranch_scc1 L_k2_hnobuild
  v_cndmask_b32 v172, v172, 0, s[66:67]
  v_cndmask_b32 v173, v173, 0, s[66:67]
  v_cndmask_b32 v174, v174, 0, s[66:67]
  v_cndmask_b32 v175, v175, 0, s[66:67]
  ds_write_b128 v8, v[176:179]
  v_alignbit_b32 v180, v171, v171, 16
  v_bfi_b32 v196, s65, v171, v170
  v_alignbit_b32 v181, v170, v170, 16
  v_bfi_b32 v197, s65, v170, v169
  v_alignbit_b32 v182, v169, v169, 16
  v_bfi_b32 v198, s65, v169, v168
  v_alignbit_b32 v183, v168, v168, 16
  v_bfi_b32 v199, s65, v168, v175
  v_alignbit_b32 v184, v175, v175, 16
  v_bfi_b32 v200, s65, v175, v174
  v_alignbit_b32 v185, v174, v174, 16
  v_bfi_b32 v201, s65, v174, v173
  v_alignbit_b32 v186, v173, v173, 16
  v_bfi_b32 v202, s65, v173, v172
  v_mov_b32 v188, v181
  v_mov_b32 v204, v197
  v_mov_b32 v189, v182
  v_mov_b32 v205, v198
  v_mov_b32 v190, v183
  v_mov_b32 v206, v199
  v_mov_b32 v191, v184
  v_mov_b32 v207, v200
  v_mov_b32 v192, v185
  v_mov_b32 v208, v201
  v_mov_b32 v193, v186
  v_mov_b32 v209, v202
  ds_write_b128 v9, v[180:183] offset:0
  ds_write_b128 v9, v[196:199] offset:4416
  ds_write_b128 v9, v[188:191] offset:8832
  ds_write_b128 v9, v[204:207] offset:13248
  ds_write_b128 v9, v[182:185] offset:17664
  ds_write_b128 v9, v[198:201] offset:22080
  ds_write_b128 v9, v[190:193] offset:26496
  ds_write_b128 v9, v[206:209] offset:30912
  v_add_u32 v9, s72, v9
  v_add_u32 v8, s73, v8
  s_sub_u32 s72, 0, s72
  s_sub_u32 s73, 0, s73
L_k2_hnobuild:
  v_mov_b32 v144, v212
  v_mov_b32 v148, v216
  v_mov_b32 v145, v213
  v_mov_b32 v149, v217
  v_mov_b32 v146, v214
  v_mov_b32 v150, v218
  v_mov_b32 v147, v215
  v_mov_b32 v151, v219
  v_mov_b32 v152, v220
  s_lshl_b32 s74, s70, 12
  v_add_u32 v14, s74, v12
  buffer_load_dwordx2 v[212:213], v14, s[44:47], 0 offen
  buffer_load_dwordx2 v[214:215], v14, s[44:47], 0 offen offset:16
  buffer_load_dwordx2 v[216:217], v14, s[52:55], 0 offen
  buffer_load_dwordx2 v[218:219], v14, s[52:55], 0 offen offset:16
  s_lshl_b32 s74, s70, 1
  v_mov_b32 v14, s74
  buffer_load_ushort v220, v14, s[56:59], 0 offen
  s_add_u32 s74, s70, 2
  s_lshl_b32 s74, s74, 12
  v_add_u32 v14, s74, v7
  v_subrev_u32 v15, 16, v14
  buffer_load_dwordx4 v[168:171], v14, s[44:47], 0 offen
  buffer_load_dwordx4 v[172:175], v15, s[44:47], 0 offen
  buffer_load_dwordx4 v[176:179], v14, s[48:51], 0 offen
  s_waitcnt lgkmcnt(0)
  s_barrier
  s_cmp_eq_u32 s71, 0
  s_cbranch_scc1 L_k2_hskip
  ds_read_b128 v[96:99], v11 offset:0
  ds_read_b128 v[100:103], v11 offset:1024
  ds_read_b128 v[104:107], v11 offset:2048
  ds_read_b128 v[108:111], v11 offset:3072
  ds_read_b128 v[112:115], v11 offset:4096
  ds_read_b128 v[116:119], v11 offset:5120
  ds_read_b128 v[120:123], v11 offset:6144
  ds_read_b128 v[124:127], v11 offset:7168
  v_lshlrev_b32 v152, 16, v152
  v_mov_b32 v153, v152
  v_mov_b32 v134, 0x3f803f80
  v_cndmask_b32 v148, v148, v134, s[76:77]
  v_mov_b32 v134, 0x3f803f80
  v_cndmask_b32 v149, v149, v134, s[76:77]
  v_mov_b32 v134, 0x3f803f80
  v_cndmask_b32 v150, v150, v134, s[76:77]
  v_mov_b32 v134, 0x3f803f80
  v_cndmask_b32 v151, v151, v134, s[76:77]
  s_waitcnt lgkmcnt(0)
  v_pk_add_f32 v[96:97], v[96:97], v[104:105]
  v_pk_add_f32 v[112:113], v[112:113], v[120:121]
  v_pk_add_f32 v[98:99], v[98:99], v[106:107]
  v_pk_add_f32 v[114:115], v[114:115], v[122:123]
  v_pk_add_f32 v[100:101], v[100:101], v[108:109]
  v_pk_add_f32 v[116:117], v[116:117], v[124:125]
  v_pk_add_f32 v[102:103], v[102:103], v[110:111]
  v_pk_add_f32 v[118:119], v[118:119], v[126:127]
  v_pk_add_f32 v[96:97], v[96:97], v[112:113]
  v_pk_add_f32 v[98:99], v[98:99], v[114:115]
  v_pk_add_f32 v[100:101], v[100:101], v[116:117]
  v_pk_add_f32 v[102:103], v[102:103], v[118:119]
  v_cvt_pk_bf16_f32 v132, v96, v97
  v_lshlrev_b32 v128, 16, v144
  v_and_b32 v129, s64, v144
  v_lshlrev_b32 v96, 16, v132
  v_and_b32 v97, s64, v132
  v_pk_mul_f32 v[128:129], v[128:129], v[152:153]
  v_cvt_pk_bf16_f32 v132, v128, v129
  v_lshlrev_b32 v128, 16, v132
  v_and_b32 v129, s64, v132
  v_pk_add_f32 v[96:97], v[96:97], v[128:129]
  v_cvt_pk_bf16_f32 v132, v96, v97
  v_lshlrev_b32 v128, 16, v148
  v_and_b32 v129, s64, v148
  v_lshlrev_b32 v96, 16, v132
  v_and_b32 v97, s64, v132
  v_pk_mul_f32 v[96:97], v[96:97], v[128:129]
  v_cvt_pk_bf16_f32 v132, v96, v97
  ds_write_b16 v13, v132 offset:0
  ds_write_b16_d16_hi v13, v132 offset:16
  v_cvt_pk_bf16_f32 v140, v98, v99
  v_lshlrev_b32 v136, 16, v145
  v_and_b32 v137, s64, v145
  v_lshlrev_b32 v98, 16, v140
  v_and_b32 v99, s64, v140
  v_pk_mul_f32 v[136:137], v[136:137], v[152:153]
  v_cvt_pk_bf16_f32 v140, v136, v137
  v_lshlrev_b32 v136, 16, v140
  v_and_b32 v137, s64, v140
  v_pk_add_f32 v[98:99], v[98:99], v[136:137]
  v_cvt_pk_bf16_f32 v140, v98, v99
  v_lshlrev_b32 v136, 16, v149
  v_and_b32 v137, s64, v149
  v_lshlrev_b32 v98, 16, v140
  v_and_b32 v99, s64, v140
  v_pk_mul_f32 v[98:99], v[98:99], v[136:137]
  v_cvt_pk_bf16_f32 v140, v98, v99
  ds_write_b16 v13, v140 offset:32
  ds_write_b16_d16_hi v13, v140 offset:48
  v_cvt_pk_bf16_f32 v132, v100, v101
  v_lshlrev_b32 v128, 16, v146
  v_and_b32 v129, s64, v146
  v_lshlrev_b32 v100, 16, v132
  v_and_b32 v101, s64, v132
  v_pk_mul_f32 v[128:129], v[128:129], v[152:153]
  v_cvt_pk_bf16_f32 v132, v128, v129
  v_lshlrev_b32 v128, 16, v132
  v_and_b32 v129, s64, v132
  v_pk_add_f32 v[100:101], v[100:101], v[128:129]
  v_cvt_pk_bf16_f32 v132, v100, v101
  v_lshlrev_b32 v128, 16, v150
  v_and_b32 v129, s64, v150
  v_lshlrev_b32 v100, 16, v132
  v_and_b32 v101, s64, v132
  v_pk_mul_f32 v[100:101], v[100:101], v[128:129]
  v_cvt_pk_bf16_f32 v132, v100, v101
  ds_write_b16 v13, v132 offset:128
  ds_write_b16_d16_hi v13, v132 offset:144
  v_cvt_pk_bf16_f32 v140, v102, v103
  v_lshlrev_b32 v136, 16, v147
  v_and_b32 v137, s64, v147
  v_lshlrev_b32 v102, 16, v140
  v_and_b32 v103, s64, v140
  v_pk_mul_f32 v[136:137], v[136:137], v[152:153]
  v_cvt_pk_bf16_f32 v140, v136, v137
  v_lshlrev_b32 v136, 16, v140
  v_and_b32 v137, s64, v140
  v_pk_add_f32 v[102:103], v[102:103], v[136:137]
  v_cvt_pk_bf16_f32 v140, v102, v103
  v_lshlrev_b32 v136, 16, v151
  v_and_b32 v137, s64, v151
  v_lshlrev_b32 v102, 16, v140
  v_and_b32 v103, s64, v140
  v_pk_mul_f32 v[102:103], v[102:103], v[136:137]
  v_cvt_pk_bf16_f32 v140, v102, v103
  ds_write_b16 v13, v140 offset:160
  ds_write_b16_d16_hi v13, v140 offset:176
  v_add_u32 v13, 2, v13
  s_waitcnt lgkmcnt(0)
L_k2_hskip:
  s_add_u32 s70, s70, 1
  s_add_u32 s71, s71, 1
  s_barrier
  s_cmp_lt_u32 s71, 8
  s_cbranch_scc1 L_k2_hloop
  s_waitcnt vmcnt(0)
  s_barrier
  ds_read_b128 v[96:99], v11 offset:0
  ds_read_b128 v[100:103], v11 offset:1024
  ds_read_b128 v[104:107], v11 offset:2048
  ds_read_b128 v[108:111], v11 offset:3072
  ds_read_b128 v[112:115], v11 offset:4096
  ds_read_b128 v[116:119], v11 offset:5120
  ds_read_b128 v[120:123], v11 offset:6144
  ds_read_b128 v[124:127], v11 offset:7168
  v_lshlrev_b32 v220, 16, v220
  v_mov_b32 v221, v220
  v_mov_b32 v134, 0x3f803f80
  v_cndmask_b32 v216, v216, v134, s[76:77]
  v_mov_b32 v134, 0x3f803f80
  v_cndmask_b32 v217, v217, v134, s[76:77]
  v_mov_b32 v134, 0x3f803f80
  v_cndmask_b32 v218, v218, v134, s[76:77]
  v_mov_b32 v134, 0x3f803f80
  v_cndmask_b32 v219, v219, v134, s[76:77]
  s_waitcnt lgkmcnt(0)
  v_pk_add_f32 v[96:97], v[96:97], v[104:105]
  v_pk_add_f32 v[112:113], v[112:113], v[120:121]
  v_pk_add_f32 v[98:99], v[98:99], v[106:107]
  v_pk_add_f32 v[114:115], v[114:115], v[122:123]
  v_pk_add_f32 v[100:101], v[100:101], v[108:109]
  v_pk_add_f32 v[116:117], v[116:117], v[124:125]
  v_pk_add_f32 v[102:103], v[102:103], v[110:111]
  v_pk_add_f32 v[118:119], v[118:119], v[126:127]
  v_pk_add_f32 v[96:97], v[96:97], v[112:113]
  v_pk_add_f32 v[98:99], v[98:99], v[114:115]
  v_pk_add_f32 v[100:101], v[100:101], v[116:117]
  v_pk_add_f32 v[102:103], v[102:103], v[118:119]
  v_cvt_pk_bf16_f32 v132, v96, v97
  v_lshlrev_b32 v128, 16, v212
  v_and_b32 v129, s64, v212
  v_lshlrev_b32 v96, 16, v132
  v_and_b32 v97, s64, v132
  v_pk_mul_f32 v[128:129], v[128:129], v[220:221]
  v_cvt_pk_bf16_f32 v132, v128, v129
  v_lshlrev_b32 v128, 16, v132
  v_and_b32 v129, s64, v132
  v_pk_add_f32 v[96:97], v[96:97], v[128:129]
  v_cvt_pk_bf16_f32 v132, v96, v97
  v_lshlrev_b32 v128, 16, v216
  v_and_b32 v129, s64, v216
  v_lshlrev_b32 v96, 16, v132
  v_and_b32 v97, s64, v132
  v_pk_mul_f32 v[96:97], v[96:97], v[128:129]
  v_cvt_pk_bf16_f32 v132, v96, v97
  ds_write_b16 v13, v132 offset:0
  ds_write_b16_d16_hi v13, v132 offset:16
  v_cvt_pk_bf16_f32 v140, v98, v99
  v_lshlrev_b32 v136, 16, v213
  v_and_b32 v137, s64, v213
  v_lshlrev_b32 v98, 16, v140
  v_and_b32 v99, s64, v140
  v_pk_mul_f32 v[136:137], v[136:137], v[220:221]
  v_cvt_pk_bf16_f32 v140, v136, v137
  v_lshlrev_b32 v136, 16, v140
  v_and_b32 v137, s64, v140
  v_pk_add_f32 v[98:99], v[98:99], v[136:137]
  v_cvt_pk_bf16_f32 v140, v98, v99
  v_lshlrev_b32 v136, 16, v217
  v_and_b32 v137, s64, v217
  v_lshlrev_b32 v98, 16, v140
  v_and_b32 v99, s64, v140
  v_pk_mul_f32 v[98:99], v[98:99], v[136:137]
  v_cvt_pk_bf16_f32 v140, v98, v99
  ds_write_b16 v13, v140 offset:32
  ds_write_b16_d16_hi v13, v140 offset:48
  v_cvt_pk_bf16_f32 v132, v100, v101
  v_lshlrev_b32 v128, 16, v214
  v_and_b32 v129, s64, v214
  v_lshlrev_b32 v100, 16, v132
  v_and_b32 v101, s64, v132
  v_pk_mul_f32 v[128:129], v[128:129], v[220:221]
  v_cvt_pk_bf16_f32 v132, v128, v129
  v_lshlrev_b32 v128, 16, v132
  v_and_b32 v129, s64, v132
  v_pk_add_f32 v[100:101], v[100:101], v[128:129]
  v_cvt_pk_bf16_f32 v132, v100, v101
  v_lshlrev_b32 v128, 16, v218
  v_and_b32 v129, s64, v218
  v_lshlrev_b32 v100, 16, v132
  v_and_b32 v101, s64, v132
  v_pk_mul_f32 v[100:101], v[100:101], v[128:129]
  v_cvt_pk_bf16_f32 v132, v100, v101
  ds_write_b16 v13, v132 offset:128
  ds_write_b16_d16_hi v13, v132 offset:144
  v_cvt_pk_bf16_f32 v140, v102, v103
  v_lshlrev_b32 v136, 16, v215
  v_and_b32 v137, s64, v215
  v_lshlrev_b32 v102, 16, v140
  v_and_b32 v103, s64, v140
  v_pk_mul_f32 v[136:137], v[136:137], v[220:221]
  v_cvt_pk_bf16_f32 v140, v136, v137
  v_lshlrev_b32 v136, 16, v140
  v_and_b32 v137, s64, v140
  v_pk_add_f32 v[102:103], v[102:103], v[136:137]
  v_cvt_pk_bf16_f32 v140, v102, v103
  v_lshlrev_b32 v136, 16, v219
  v_and_b32 v137, s64, v219
  v_lshlrev_b32 v102, 16, v140
  v_and_b32 v103, s64, v140
  v_pk_mul_f32 v[102:103], v[102:103], v[136:137]
  v_cvt_pk_bf16_f32 v140, v102, v103
  ds_write_b16 v13, v140 offset:160
  ds_write_b16_d16_hi v13, v140 offset:176
  v_add_u32 v13, 2, v13
  s_waitcnt lgkmcnt(0)
L_k2_final:
  s_barrier
  v_lshlrev_b32 v14, 4, v229
  v_lshrrev_b32 v15, 6, v229
  v_lshl_add_u32 v14, v15, 4, v14
  v_add_u32 v14, 121568, v14
  ds_read_b128 v[96:99], v14 offset:0
  ds_read_b128 v[100:103], v14 offset:8320
  ds_read_b128 v[104:107], v14 offset:16640
  ds_read_b128 v[108:111], v14 offset:24960
  s_lshl_b32 s3, s41, 11
  s_lshl_b32 s74, s42, 1
  s_add_u32 s3, s3, s74
  v_lshlrev_b32 v15, 12, v229
  v_add_u32 v15, s3, v15
  s_waitcnt lgkmcnt(3)
  v_add_u32 v14, 0x0, v15
  buffer_store_dwordx4 v[96:99], v14, s[60:63], 0 offen
  s_waitcnt lgkmcnt(2)
  v_add_u32 v14, 0x200000, v15
  buffer_store_dwordx4 v[100:103], v14, s[60:63], 0 offen
  s_waitcnt lgkmcnt(1)
  v_add_u32 v14, 0x400000, v15
  buffer_store_dwordx4 v[104:107], v14, s[60:63], 0 offen
  s_waitcnt lgkmcnt(0)
  v_add_u32 v14, 0x600000, v15
  buffer_store_dwordx4 v[108:111], v14, s[60:63], 0 offen
L_k2_end:
  s_endpgm
.section .rodata,"a"
.p2align 6
.amdhsa_kernel prep_kernel
  .amdhsa_next_free_vgpr 128
  .amdhsa_next_free_sgpr 102
  .amdhsa_accum_offset 128
  .amdhsa_group_segment_fixed_size 0
  .amdhsa_kernarg_size 128
  .amdhsa_user_sgpr_count 2
  .amdhsa_user_sgpr_kernarg_segment_ptr 1
  .amdhsa_system_sgpr_workgroup_id_x 1
  .amdhsa_float_denorm_mode_32 3
.end_amdhsa_kernel
.p2align 6
.amdhsa_kernel conv_kernel
  .amdhsa_next_free_vgpr 232
  .amdhsa_next_free_sgpr 102
  .amdhsa_accum_offset 232
  .amdhsa_group_segment_fixed_size 0
  .amdhsa_kernarg_size 128
  .amdhsa_user_sgpr_count 2
  .amdhsa_user_sgpr_kernarg_segment_ptr 1
  .amdhsa_system_sgpr_workgroup_id_x 1
  .amdhsa_float_denorm_mode_32 3
.end_amdhsa_kernel
```
